```python
import torch

def _softmax(x, axis=-1):
    return torch.softmax(x, dim=axis)
def _gelu(x):
    return torch.nn.functional.gelu(x, approximate="tanh")
def _silu(x):
    return torch.nn.functional.silu(x)
def _sigmoid(x):
    return torch.sigmoid(x)
def _layernorm(x, axis=-1, eps=1e-5):
    m = x.mean(dim=axis, keepdim=True)
    v = x.var(dim=axis, keepdim=True, unbiased=False)
    return (x - m) / torch.sqrt(v + eps)
def _scatter_add(tgt, idx, src, axis=0):
    return tgt.clone().index_add_(axis, idx, src)
def _segment_sum(src, seg, n):
    out = torch.zeros((n,) + src.shape[1:], dtype=src.dtype)
    return out.index_add_(0, seg, src)
def _pad(x, pw):
    flat = tuple(v for pair in reversed(pw) for v in pair)
    return torch.nn.functional.pad(x, flat)

kernel_name = 'gated_mix__mha_block_cached__gqa_block_cached__decode'

def setup_inputs():

    _w = (lambda a: (lambda t: t.to(torch.bfloat16) if t.is_floating_point() else t)(torch.as_tensor(a)))
    def _A_setup():
        B, Sq, D = 4, 1, 512
        H, Sk, Dh = 32, 8192, 128
        return {
            "x": _w((lambda *s: torch.randn(*s, dtype=torch.bfloat16) * 0.05)(B, Sq, D)),
            "k_cache": _w((lambda *s: torch.randn(*s, dtype=torch.bfloat16) * 6.4)(B, H, Sk, Dh)),
            "v_cache": _w((lambda *s: torch.randn(*s, dtype=torch.bfloat16) * 0.05)(B, H, Sk, Dh)),
            "wq": _w((lambda *s: torch.randn(*s, dtype=torch.bfloat16) * 6.4)(D, H * Dh) * (D ** -0.5)),
            "wo": _w((lambda *s: torch.randn(*s, dtype=torch.bfloat16) * 0.05)(H * Dh, D) * ((H * Dh) ** -0.5)),
        }
    _A_in = _A_setup()

    def _B_setup():
        B, Sq, D = 4, 1, 512
        Hq, Hkv, Sk, Dh = 32, 8, 8192, 128
        assert Hq % Hkv == 0, (Hq, Hkv)
        return {
            "x": _w((lambda *s: torch.randn(*s, dtype=torch.bfloat16) * 0.05)(B, Sq, D)),
            "k_cache": _w((lambda *s: torch.randn(*s, dtype=torch.bfloat16) * 6.4)(B, Hkv, Sk, Dh)),
            "v_cache": _w((lambda *s: torch.randn(*s, dtype=torch.bfloat16) * 0.05)(B, Hkv, Sk, Dh)),
            "wq": _w((lambda *s: torch.randn(*s, dtype=torch.bfloat16) * 6.4)(D, Hq * Dh) * (D ** -0.5)),
            "wo": _w((lambda *s: torch.randn(*s, dtype=torch.bfloat16) * 0.05)(Hq * Dh, D) * ((Hq * Dh) ** -0.5)),
        }
    _B_in = _B_setup()

    return {
        "A_x": _A_in["x"],
        "A_k_cache": _A_in["k_cache"],
        "A_v_cache": _A_in["v_cache"],
        "A_wq": _A_in["wq"],
        "A_wo": _A_in["wo"],
        "B_x": _B_in["x"],
        "B_k_cache": _B_in["k_cache"],
        "B_v_cache": _B_in["v_cache"],
        "B_wq": _B_in["wq"],
        "B_wo": _B_in["wo"],
        "gate_w": _w((lambda *s: torch.randn(*s, dtype=torch.bfloat16) * 0.1)(512) * 16.0),
    }

def reference(A_x, A_k_cache, A_v_cache, A_wq, A_wo, B_x, B_k_cache, B_v_cache, B_wq, B_wo, gate_w):
    def _A_ref(x, k_cache, v_cache, wq, wo):
        B, Sq, D = x.shape
        H, Dh = 32, 128
        q = (lambda x, *d: x.permute(*d))((x @ wq).reshape(B, Sq, H, Dh), 0, 2, 1, 3)
        scores = torch.einsum("bhqd,bhkd->bhqk", q, k_cache) * (Dh ** -0.5)
        p = _softmax(scores, axis=-1)
        o = torch.einsum("bhqk,bhkd->bhqd", p, v_cache)
        return (lambda x, *d: x.permute(*d))(o, 0, 2, 1, 3).reshape(B, Sq, H * Dh) @ wo

    def _B_ref(x, k_cache, v_cache, wq, wo):
        B, Sq, D = x.shape
        Hq, Dh = 32, 128
        Hkv = k_cache.shape[1]
        rep = Hq // Hkv
        q = (lambda x, *d: x.permute(*d))((x @ wq).reshape(B, Sq, Hq, Dh), 0, 2, 1, 3)
        k = (lambda x, n, axis: torch.repeat_interleave(x, n, dim=axis))(k_cache, rep, axis=1)
        v = (lambda x, n, axis: torch.repeat_interleave(x, n, dim=axis))(v_cache, rep, axis=1)
        scores = torch.einsum("bhqd,bhkd->bhqk", q, k) * (Dh ** -0.5)
        p = _softmax(scores, axis=-1)
        o = torch.einsum("bhqk,bhkd->bhqd", p, v)
        return (lambda x, *d: x.permute(*d))(o, 0, 2, 1, 3).reshape(B, Sq, Hq * Dh) @ wo

    x = A_x
    g = _sigmoid((x * gate_w).sum(-1, keepdims=True))
    a = _A_ref(x, A_k_cache, A_v_cache, A_wq, A_wo)
    b = _B_ref(x, B_k_cache, B_v_cache, B_wq, B_wo)
    return g * a + (1 - g) * b
```

```asm
; @launch grid=(256,1,1) block=(256,1,1) lds=16384
.amdgcn_target "amdgcn-amd-amdhsa--gfx950"
.text
.globl gated_mix__mha_block_cached__gqa_block_cached__decode_kernel
.p2align 8
.type gated_mix__mha_block_cached__gqa_block_cached__decode_kernel,@function
gated_mix__mha_block_cached__gqa_block_cached__decode_kernel:
  s_cmp_ge_u32 s2, 256
  s_cbranch_scc1 L_end
  s_load_dwordx16 s[44:59], s[0:1], 0
  s_load_dwordx8 s[60:67], s[0:1], 64
  s_load_dwordx4 s[68:71], s[0:1], 96
  s_getpc_b64 s[90:91]
L_pc:
  s_sub_u32 s90, s90, L_pc-gated_mix__mha_block_cached__gqa_block_cached__decode_kernel
  s_subb_u32 s91, s91, 0
  s_lshr_b32 s92, s2, 3
  s_lshl_b32 s92, s92, 10
  s_cmp_lt_u32 s92, L_code_end-gated_mix__mha_block_cached__gqa_block_cached__decode_kernel-1024
  s_cbranch_scc0 L_nopf
  v_cmp_gt_u32 vcc, 64, v0
  s_and_saveexec_b64 s[86:87], vcc
  s_cbranch_execz L_pf_restore
  v_lshl_add_u32 v250, v0, 4, s92
  global_load_dwordx4 v[252:255], v250, s[90:91]
L_pf_restore:
  s_mov_b64 exec, s[86:87]
L_nopf:
  v_lshrrev_b32 v1, 6, v0
  v_and_b32 v0, 63, v0
  v_and_b32 v3, 15, v0
  v_readfirstlane_b32 s3, v1
  v_lshrrev_b32 v2, 4, v0
  s_waitcnt lgkmcnt(0)
  s_cmp_ge_u32 s3, 2
  s_cbranch_scc1 L_H
  s_and_b32 s4, s2, 127
  s_lshl_b32 s4, s4, 21
  s_lshr_b32 s5, s2, 7
  s_lshl_b32 s33, s5, 1
  s_add_u32 s33, s33, s3
  s_lshl_b32 s33, s33, 13
  s_add_u32 s8, s46, s4
  s_addc_u32 s9, s47, 0
  s_and_b32 s9, s9, 0xffff
  s_mov_b32 s10, 2097152
  s_mov_b32 s11, 0x20000
  s_add_u32 s12, s48, s4
  s_addc_u32 s13, s49, 0
  s_and_b32 s13, s13, 0xffff
  s_mov_b32 s14, 2097152
  s_mov_b32 s15, 0x20000
  s_mov_b32 s24, s33
  s_add_u32 s25, s24, 4096
  v_lshlrev_b32 v4, 8, v3
  v_lshl_add_u32 v4, v2, 4, v4
  v_lshlrev_b32 v5, 10, v2
  v_lshl_add_u32 v5, v3, 4, v5
  s_mov_b32 s35, 32768
  s_barrier
  buffer_load_dwordx4 a[0:3], v4, s[8:11], s24 offen offset:0 nt
  buffer_load_dwordx4 a[4:7], v4, s[8:11], s24 offen offset:64 nt
  buffer_load_dwordx4 a[8:11], v4, s[8:11], s24 offen offset:128 nt
  buffer_load_dwordx4 a[12:15], v4, s[8:11], s24 offen offset:192 nt
  buffer_load_dwordx4 a[16:19], v4, s[8:11], s25 offen offset:0 nt
  buffer_load_dwordx4 a[20:23], v4, s[8:11], s25 offen offset:64 nt
  buffer_load_dwordx4 a[24:27], v4, s[8:11], s25 offen offset:128 nt
  buffer_load_dwordx4 a[28:31], v4, s[8:11], s25 offen offset:192 nt
  buffer_load_dwordx4 v[96:99], v5, s[12:15], s24 offen offset:0 nt
  buffer_load_dwordx4 v[100:103], v5, s[12:15], s24 offen offset:256 nt
  buffer_load_dwordx4 v[104:107], v5, s[12:15], s24 offen offset:512 nt
  buffer_load_dwordx4 v[108:111], v5, s[12:15], s24 offen offset:768 nt
  buffer_load_dwordx4 v[112:115], v5, s[12:15], s25 offen offset:0 nt
  buffer_load_dwordx4 v[116:119], v5, s[12:15], s25 offen offset:256 nt
  buffer_load_dwordx4 v[120:123], v5, s[12:15], s25 offen offset:512 nt
  buffer_load_dwordx4 v[124:127], v5, s[12:15], s25 offen offset:768 nt
  s_add_u32 s24, s24, s35
  s_add_u32 s25, s25, s35
  s_mov_b32 s16, s8
  s_mov_b32 s17, s9
  s_mov_b32 s18, s12
  s_mov_b32 s19, s13
  s_lshr_b32 s5, s2, 1
  s_lshl_b32 s5, s5, 19
  s_and_b32 s34, s2, 1
  s_lshl_b32 s34, s34, 1
  s_add_u32 s34, s34, s3
  s_lshl_b32 s34, s34, 13
  s_add_u32 s20, s56, s5
  s_addc_u32 s21, s57, 0
  s_and_b32 s21, s21, 0xffff
  s_add_u32 s22, s58, s5
  s_addc_u32 s23, s59, 0
  s_and_b32 s23, s23, 0xffff
  s_mov_b32 s28, 0x3db504f3
  s_mov_b32 s29, 0x3fb8aa3b
  s_mov_b32 s30, 0x5040100
  s_mov_b32 s31, 0x7060302
  s_mov_b32 s32, 0xffff0000
  s_mov_b32 s36, 0x000f000f
  s_mov_b32 s37, 0x000f000f
  v_and_b32 v10, 3, v3
  s_lshl_b32 s4, s3, 11
  v_lshlrev_b32 v6, 9, v10
  v_lshl_add_u32 v6, v2, 4, v6
  v_add_u32 v6, s4, v6
  s_lshl_b32 s4, s3, 7
  v_lshlrev_b32 v7, 5, v10
  v_lshl_add_u32 v7, v2, 2, v7
  v_add_u32 v7, s4, v7
  v_lshlrev_b32 v8, 4, v2
  v_lshl_add_u32 v9, v10, 8, v8
  v_mov_b32 v48, 0
  v_mov_b32 v49, 0
  v_mov_b32 v50, 0
  v_mov_b32 v51, 0
  v_mov_b32 v52, 0
  v_mov_b32 v53, 0
  v_mov_b32 v54, 0
  v_mov_b32 v55, 0
  v_mov_b32 v56, 0
  v_mov_b32 v57, 0
  v_mov_b32 v58, 0
  v_mov_b32 v59, 0
  v_mov_b32 v60, 0
  v_mov_b32 v61, 0
  v_mov_b32 v62, 0
  v_mov_b32 v63, 0
  v_mov_b32 v64, 0
  v_mov_b32 v65, 0
  v_mov_b32 v66, 0
  v_mov_b32 v67, 0
  v_mov_b32 v68, 0
  v_mov_b32 v69, 0
  v_mov_b32 v70, 0
  v_mov_b32 v71, 0
  v_mov_b32 v72, 0
  v_mov_b32 v73, 0
  v_mov_b32 v74, 0
  v_mov_b32 v75, 0
  v_mov_b32 v76, 0
  v_mov_b32 v77, 0
  v_mov_b32 v78, 0
  v_mov_b32 v79, 0
  v_mov_b32 v80, 0xff800000
  v_mov_b32 v84, 0xff800000
  v_mov_b32 v81, 0
  s_barrier
  s_barrier
  buffer_load_dwordx4 a[32:35], v4, s[8:11], s24 offen offset:0 nt
  buffer_load_dwordx4 a[36:39], v4, s[8:11], s24 offen offset:64 nt
  buffer_load_dwordx4 a[40:43], v4, s[8:11], s24 offen offset:128 nt
  buffer_load_dwordx4 a[44:47], v4, s[8:11], s24 offen offset:192 nt
  buffer_load_dwordx4 a[48:51], v4, s[8:11], s25 offen offset:0 nt
  buffer_load_dwordx4 a[52:55], v4, s[8:11], s25 offen offset:64 nt
  buffer_load_dwordx4 a[56:59], v4, s[8:11], s25 offen offset:128 nt
  buffer_load_dwordx4 a[60:63], v4, s[8:11], s25 offen offset:192 nt
  buffer_load_dwordx4 v[128:131], v5, s[12:15], s24 offen offset:0 nt
  buffer_load_dwordx4 v[132:135], v5, s[12:15], s24 offen offset:256 nt
  buffer_load_dwordx4 v[136:139], v5, s[12:15], s24 offen offset:512 nt
  buffer_load_dwordx4 v[140:143], v5, s[12:15], s24 offen offset:768 nt
  buffer_load_dwordx4 v[144:147], v5, s[12:15], s25 offen offset:0 nt
  buffer_load_dwordx4 v[148:151], v5, s[12:15], s25 offen offset:256 nt
  buffer_load_dwordx4 v[152:155], v5, s[12:15], s25 offen offset:512 nt
  buffer_load_dwordx4 v[156:159], v5, s[12:15], s25 offen offset:768 nt
  s_add_u32 s24, s24, s35
  s_add_u32 s25, s25, s35
  s_barrier
  ds_read_b128 v[12:15], v8 offset:0
  ds_read_b128 v[16:19], v8 offset:64
  ds_read_b128 v[20:23], v8 offset:128
  ds_read_b128 v[24:27], v8 offset:192
  s_mov_b32 s27, 0
  s_mov_b32 s26, 12
  s_waitcnt lgkmcnt(0)
L_sloop:
  s_cmp_eq_u32 s27, 0
  s_cbranch_scc0 L_nobm
  s_cmp_eq_u32 s26, 4
  s_cbranch_scc0 L_nobm
  s_barrier
L_nobm:
  s_cmp_eq_u32 s26, 1
  s_cbranch_scc0 L_noswitch
  s_cmp_eq_u32 s27, 0
  s_cbranch_scc0 L_sw1
  s_mov_b32 s8, s20
  s_mov_b32 s9, s21
  s_mov_b32 s10, 524288
  s_mov_b32 s12, s22
  s_mov_b32 s13, s23
  s_mov_b32 s14, 524288
  s_mov_b32 s35, 32768
  s_add_u32 s24, s34, 0
  s_add_u32 s25, s24, 4096
  s_branch L_noswitch
L_sw1:
  s_cmp_eq_u32 s27, 1
  s_cbranch_scc0 L_sw2
  s_mov_b32 s8, s16
  s_mov_b32 s9, s17
  s_mov_b32 s10, 2097152
  s_mov_b32 s12, s18
  s_mov_b32 s13, s19
  s_mov_b32 s14, 2097152
  s_mov_b32 s35, 32768
  s_add_u32 s24, s33, 786432
  s_add_u32 s25, s24, 4096
  s_branch L_noswitch
L_sw2:
  s_mov_b32 s10, 0
  s_mov_b32 s14, 0
  s_barrier
L_noswitch:
  s_waitcnt vmcnt(24)
  v_mfma_f32_16x16x32_bf16 v[28:31], a[0:3], v[12:15], 0
  v_mfma_f32_16x16x32_bf16 v[32:35], a[16:19], v[12:15], 0
  v_mfma_f32_16x16x32_bf16 v[28:31], a[4:7], v[16:19], v[28:31]
  v_mfma_f32_16x16x32_bf16 v[32:35], a[20:23], v[16:19], v[32:35]
  v_mfma_f32_16x16x32_bf16 v[28:31], a[8:11], v[20:23], v[28:31]
  v_mfma_f32_16x16x32_bf16 v[32:35], a[24:27], v[20:23], v[32:35]
  v_mfma_f32_16x16x32_bf16 v[28:31], a[12:15], v[24:27], v[28:31]
  v_mfma_f32_16x16x32_bf16 v[32:35], a[28:31], v[24:27], v[32:35]
  buffer_load_dwordx4 a[0:3], v4, s[8:11], s24 offen offset:0 nt
  buffer_load_dwordx4 a[4:7], v4, s[8:11], s24 offen offset:64 nt
  buffer_load_dwordx4 a[8:11], v4, s[8:11], s24 offen offset:128 nt
  buffer_load_dwordx4 a[12:15], v4, s[8:11], s24 offen offset:192 nt
  buffer_load_dwordx4 a[16:19], v4, s[8:11], s25 offen offset:0 nt
  buffer_load_dwordx4 a[20:23], v4, s[8:11], s25 offen offset:64 nt
  buffer_load_dwordx4 a[24:27], v4, s[8:11], s25 offen offset:128 nt
  buffer_load_dwordx4 a[28:31], v4, s[8:11], s25 offen offset:192 nt
  s_nop 1
  v_cvt_pk_bf16_f32 v86, v28, v29
  v_cvt_pk_bf16_f32 v87, v30, v31
  v_cvt_pk_bf16_f32 v88, v32, v33
  v_cvt_pk_bf16_f32 v89, v34, v35
  v_lshlrev_b32 v28, 16, v86
  v_and_b32 v29, s32, v86
  v_lshlrev_b32 v30, 16, v87
  v_and_b32 v31, s32, v87
  v_lshlrev_b32 v32, 16, v88
  v_and_b32 v33, s32, v88
  v_lshlrev_b32 v34, 16, v89
  v_and_b32 v35, s32, v89
  v_mul_f32 v28, s28, v28
  v_mul_f32 v29, s28, v29
  v_mul_f32 v30, s28, v30
  v_mul_f32 v31, s28, v31
  v_mul_f32 v32, s28, v32
  v_mul_f32 v33, s28, v33
  v_mul_f32 v34, s28, v34
  v_mul_f32 v35, s28, v35
  v_cvt_pk_bf16_f32 v86, v28, v29
  v_cvt_pk_bf16_f32 v87, v30, v31
  v_cvt_pk_bf16_f32 v88, v32, v33
  v_cvt_pk_bf16_f32 v89, v34, v35
  v_lshlrev_b32 v28, 16, v86
  v_and_b32 v29, s32, v86
  v_lshlrev_b32 v30, 16, v87
  v_and_b32 v31, s32, v87
  v_lshlrev_b32 v32, 16, v88
  v_and_b32 v33, s32, v88
  v_lshlrev_b32 v34, 16, v89
  v_and_b32 v35, s32, v89
  v_max3_f32 v86, v28, v29, v30
  v_max3_f32 v87, v31, v32, v33
  v_max3_f32 v86, v86, v34, v35
  v_max_f32 v86, v86, v87
  v_mov_b32 v87, v86
  s_nop 1
  v_permlane32_swap_b32 v86, v87
  v_max_f32 v86, v86, v87
  v_mov_b32 v87, v86
  s_nop 1
  v_permlane16_swap_b32 v86, v87
  v_max_f32 v86, v86, v87
  v_max_f32 v82, v80, v86
  v_cmp_gt_f32 vcc, v82, v80
  s_cbranch_vccz L_nors_1
  v_sub_f32 v87, v80, v82
  v_mul_f32 v87, s29, v87
  v_exp_f32 v83, v87
  v_mov_b32 v80, v82
  v_mul_f32 v84, s29, v82
  v_mul_f32 v81, v81, v83
  v_mul_f32 v48, v48, v83
  v_mul_f32 v49, v49, v83
  v_mul_f32 v50, v50, v83
  v_mul_f32 v51, v51, v83
  v_mul_f32 v52, v52, v83
  v_mul_f32 v53, v53, v83
  v_mul_f32 v54, v54, v83
  v_mul_f32 v55, v55, v83
  v_mul_f32 v56, v56, v83
  v_mul_f32 v57, v57, v83
  v_mul_f32 v58, v58, v83
  v_mul_f32 v59, v59, v83
  v_mul_f32 v60, v60, v83
  v_mul_f32 v61, v61, v83
  v_mul_f32 v62, v62, v83
  v_mul_f32 v63, v63, v83
  v_mul_f32 v64, v64, v83
  v_mul_f32 v65, v65, v83
  v_mul_f32 v66, v66, v83
  v_mul_f32 v67, v67, v83
  v_mul_f32 v68, v68, v83
  v_mul_f32 v69, v69, v83
  v_mul_f32 v70, v70, v83
  v_mul_f32 v71, v71, v83
  v_mul_f32 v72, v72, v83
  v_mul_f32 v73, v73, v83
  v_mul_f32 v74, v74, v83
  v_mul_f32 v75, v75, v83
  v_mul_f32 v76, v76, v83
  v_mul_f32 v77, v77, v83
  v_mul_f32 v78, v78, v83
  v_mul_f32 v79, v79, v83
L_nors_1:
  v_fma_f32 v28, v28, s29, -v84
  v_fma_f32 v29, v29, s29, -v84
  v_fma_f32 v30, v30, s29, -v84
  v_fma_f32 v31, v31, s29, -v84
  v_fma_f32 v32, v32, s29, -v84
  v_fma_f32 v33, v33, s29, -v84
  v_fma_f32 v34, v34, s29, -v84
  v_fma_f32 v35, v35, s29, -v84
  v_exp_f32 v28, v28
  v_exp_f32 v29, v29
  v_exp_f32 v30, v30
  v_exp_f32 v31, v31
  v_exp_f32 v32, v32
  v_exp_f32 v33, v33
  v_exp_f32 v34, v34
  v_exp_f32 v35, v35
  v_add_f32 v86, v28, v29
  v_add_f32 v87, v30, v31
  v_add_f32 v88, v32, v33
  v_add_f32 v89, v34, v35
  v_cvt_pk_bf16_f32 v36, v28, v29
  v_cvt_pk_bf16_f32 v37, v30, v31
  v_cvt_pk_bf16_f32 v38, v32, v33
  v_cvt_pk_bf16_f32 v39, v34, v35
  v_add_f32 v86, v86, v87
  v_add_f32 v88, v88, v89
  v_add_f32 v86, v86, v88
  v_add_f32 v81, v81, v86
  s_waitcnt vmcnt(24)
  v_perm_b32 v40, v100, v96, s30
  v_perm_b32 v41, v108, v104, s30
  v_perm_b32 v42, v116, v112, s30
  v_perm_b32 v43, v124, v120, s30
  v_perm_b32 v44, v100, v96, s31
  v_perm_b32 v45, v108, v104, s31
  v_perm_b32 v46, v116, v112, s31
  v_perm_b32 v47, v124, v120, s31
  v_mfma_f32_16x16x32_bf16 v[48:51], v[40:43], v[36:39], v[48:51]
  v_perm_b32 v40, v101, v97, s30
  v_perm_b32 v41, v109, v105, s30
  v_perm_b32 v42, v117, v113, s30
  v_perm_b32 v43, v125, v121, s30
  v_mfma_f32_16x16x32_bf16 v[52:55], v[44:47], v[36:39], v[52:55]
  v_perm_b32 v44, v101, v97, s31
  v_perm_b32 v45, v109, v105, s31
  v_perm_b32 v46, v117, v113, s31
  v_perm_b32 v47, v125, v121, s31
  v_mfma_f32_16x16x32_bf16 v[56:59], v[40:43], v[36:39], v[56:59]
  v_perm_b32 v40, v102, v98, s30
  v_perm_b32 v41, v110, v106, s30
  v_perm_b32 v42, v118, v114, s30
  v_perm_b32 v43, v126, v122, s30
  v_mfma_f32_16x16x32_bf16 v[60:63], v[44:47], v[36:39], v[60:63]
  v_perm_b32 v44, v102, v98, s31
  v_perm_b32 v45, v110, v106, s31
  v_perm_b32 v46, v118, v114, s31
  v_perm_b32 v47, v126, v122, s31
  v_mfma_f32_16x16x32_bf16 v[64:67], v[40:43], v[36:39], v[64:67]
  v_perm_b32 v40, v103, v99, s30
  v_perm_b32 v41, v111, v107, s30
  v_perm_b32 v42, v119, v115, s30
  v_perm_b32 v43, v127, v123, s30
  v_mfma_f32_16x16x32_bf16 v[68:71], v[44:47], v[36:39], v[68:71]
  v_perm_b32 v44, v103, v99, s31
  v_perm_b32 v45, v111, v107, s31
  v_perm_b32 v46, v119, v115, s31
  v_perm_b32 v47, v127, v123, s31
  v_mfma_f32_16x16x32_bf16 v[72:75], v[40:43], v[36:39], v[72:75]
  s_nop 0
  v_mfma_f32_16x16x32_bf16 v[76:79], v[44:47], v[36:39], v[76:79]
  buffer_load_dwordx4 v[96:99], v5, s[12:15], s24 offen offset:0 nt
  buffer_load_dwordx4 v[100:103], v5, s[12:15], s24 offen offset:256 nt
  buffer_load_dwordx4 v[104:107], v5, s[12:15], s24 offen offset:512 nt
  buffer_load_dwordx4 v[108:111], v5, s[12:15], s24 offen offset:768 nt
  buffer_load_dwordx4 v[112:115], v5, s[12:15], s25 offen offset:0 nt
  buffer_load_dwordx4 v[116:119], v5, s[12:15], s25 offen offset:256 nt
  buffer_load_dwordx4 v[120:123], v5, s[12:15], s25 offen offset:512 nt
  buffer_load_dwordx4 v[124:127], v5, s[12:15], s25 offen offset:768 nt
  s_add_u32 s24, s24, s35
  s_add_u32 s25, s25, s35
  s_waitcnt vmcnt(24)
  v_mfma_f32_16x16x32_bf16 v[28:31], a[32:35], v[12:15], 0
  v_mfma_f32_16x16x32_bf16 v[32:35], a[48:51], v[12:15], 0
  v_mfma_f32_16x16x32_bf16 v[28:31], a[36:39], v[16:19], v[28:31]
  v_mfma_f32_16x16x32_bf16 v[32:35], a[52:55], v[16:19], v[32:35]
  v_mfma_f32_16x16x32_bf16 v[28:31], a[40:43], v[20:23], v[28:31]
  v_mfma_f32_16x16x32_bf16 v[32:35], a[56:59], v[20:23], v[32:35]
  v_mfma_f32_16x16x32_bf16 v[28:31], a[44:47], v[24:27], v[28:31]
  v_mfma_f32_16x16x32_bf16 v[32:35], a[60:63], v[24:27], v[32:35]
  buffer_load_dwordx4 a[32:35], v4, s[8:11], s24 offen offset:0 nt
  buffer_load_dwordx4 a[36:39], v4, s[8:11], s24 offen offset:64 nt
  buffer_load_dwordx4 a[40:43], v4, s[8:11], s24 offen offset:128 nt
  buffer_load_dwordx4 a[44:47], v4, s[8:11], s24 offen offset:192 nt
  buffer_load_dwordx4 a[48:51], v4, s[8:11], s25 offen offset:0 nt
  buffer_load_dwordx4 a[52:55], v4, s[8:11], s25 offen offset:64 nt
  buffer_load_dwordx4 a[56:59], v4, s[8:11], s25 offen offset:128 nt
  buffer_load_dwordx4 a[60:63], v4, s[8:11], s25 offen offset:192 nt
  s_nop 1
  v_cvt_pk_bf16_f32 v86, v28, v29
  v_cvt_pk_bf16_f32 v87, v30, v31
  v_cvt_pk_bf16_f32 v88, v32, v33
  v_cvt_pk_bf16_f32 v89, v34, v35
  v_lshlrev_b32 v28, 16, v86
  v_and_b32 v29, s32, v86
  v_lshlrev_b32 v30, 16, v87
  v_and_b32 v31, s32, v87
  v_lshlrev_b32 v32, 16, v88
  v_and_b32 v33, s32, v88
  v_lshlrev_b32 v34, 16, v89
  v_and_b32 v35, s32, v89
  v_mul_f32 v28, s28, v28
  v_mul_f32 v29, s28, v29
  v_mul_f32 v30, s28, v30
  v_mul_f32 v31, s28, v31
  v_mul_f32 v32, s28, v32
  v_mul_f32 v33, s28, v33
  v_mul_f32 v34, s28, v34
  v_mul_f32 v35, s28, v35
  v_cvt_pk_bf16_f32 v86, v28, v29
  v_cvt_pk_bf16_f32 v87, v30, v31
  v_cvt_pk_bf16_f32 v88, v32, v33
  v_cvt_pk_bf16_f32 v89, v34, v35
  v_lshlrev_b32 v28, 16, v86
  v_and_b32 v29, s32, v86
  v_lshlrev_b32 v30, 16, v87
  v_and_b32 v31, s32, v87
  v_lshlrev_b32 v32, 16, v88
  v_and_b32 v33, s32, v88
  v_lshlrev_b32 v34, 16, v89
  v_and_b32 v35, s32, v89
  v_max3_f32 v86, v28, v29, v30
  v_max3_f32 v87, v31, v32, v33
  v_max3_f32 v86, v86, v34, v35
  v_max_f32 v86, v86, v87
  v_mov_b32 v87, v86
  s_nop 1
  v_permlane32_swap_b32 v86, v87
  v_max_f32 v86, v86, v87
  v_mov_b32 v87, v86
  s_nop 1
  v_permlane16_swap_b32 v86, v87
  v_max_f32 v86, v86, v87
  v_max_f32 v82, v80, v86
  v_cmp_gt_f32 vcc, v82, v80
  s_cbranch_vccz L_nors_2
  v_sub_f32 v87, v80, v82
  v_mul_f32 v87, s29, v87
  v_exp_f32 v83, v87
  v_mov_b32 v80, v82
  v_mul_f32 v84, s29, v82
  v_mul_f32 v81, v81, v83
  v_mul_f32 v48, v48, v83
  v_mul_f32 v49, v49, v83
  v_mul_f32 v50, v50, v83
  v_mul_f32 v51, v51, v83
  v_mul_f32 v52, v52, v83
  v_mul_f32 v53, v53, v83
  v_mul_f32 v54, v54, v83
  v_mul_f32 v55, v55, v83
  v_mul_f32 v56, v56, v83
  v_mul_f32 v57, v57, v83
  v_mul_f32 v58, v58, v83
  v_mul_f32 v59, v59, v83
  v_mul_f32 v60, v60, v83
  v_mul_f32 v61, v61, v83
  v_mul_f32 v62, v62, v83
  v_mul_f32 v63, v63, v83
  v_mul_f32 v64, v64, v83
  v_mul_f32 v65, v65, v83
  v_mul_f32 v66, v66, v83
  v_mul_f32 v67, v67, v83
  v_mul_f32 v68, v68, v83
  v_mul_f32 v69, v69, v83
  v_mul_f32 v70, v70, v83
  v_mul_f32 v71, v71, v83
  v_mul_f32 v72, v72, v83
  v_mul_f32 v73, v73, v83
  v_mul_f32 v74, v74, v83
  v_mul_f32 v75, v75, v83
  v_mul_f32 v76, v76, v83
  v_mul_f32 v77, v77, v83
  v_mul_f32 v78, v78, v83
  v_mul_f32 v79, v79, v83
L_nors_2:
  v_fma_f32 v28, v28, s29, -v84
  v_fma_f32 v29, v29, s29, -v84
  v_fma_f32 v30, v30, s29, -v84
  v_fma_f32 v31, v31, s29, -v84
  v_fma_f32 v32, v32, s29, -v84
  v_fma_f32 v33, v33, s29, -v84
  v_fma_f32 v34, v34, s29, -v84
  v_fma_f32 v35, v35, s29, -v84
  v_exp_f32 v28, v28
  v_exp_f32 v29, v29
  v_exp_f32 v30, v30
  v_exp_f32 v31, v31
  v_exp_f32 v32, v32
  v_exp_f32 v33, v33
  v_exp_f32 v34, v34
  v_exp_f32 v35, v35
  v_add_f32 v86, v28, v29
  v_add_f32 v87, v30, v31
  v_add_f32 v88, v32, v33
  v_add_f32 v89, v34, v35
  v_cvt_pk_bf16_f32 v36, v28, v29
  v_cvt_pk_bf16_f32 v37, v30, v31
  v_cvt_pk_bf16_f32 v38, v32, v33
  v_cvt_pk_bf16_f32 v39, v34, v35
  v_add_f32 v86, v86, v87
  v_add_f32 v88, v88, v89
  v_add_f32 v86, v86, v88
  v_add_f32 v81, v81, v86
  s_waitcnt vmcnt(24)
  v_perm_b32 v40, v132, v128, s30
  v_perm_b32 v41, v140, v136, s30
  v_perm_b32 v42, v148, v144, s30
  v_perm_b32 v43, v156, v152, s30
  v_perm_b32 v44, v132, v128, s31
  v_perm_b32 v45, v140, v136, s31
  v_perm_b32 v46, v148, v144, s31
  v_perm_b32 v47, v156, v152, s31
  v_mfma_f32_16x16x32_bf16 v[48:51], v[40:43], v[36:39], v[48:51]
  v_perm_b32 v40, v133, v129, s30
  v_perm_b32 v41, v141, v137, s30
  v_perm_b32 v42, v149, v145, s30
  v_perm_b32 v43, v157, v153, s30
  v_mfma_f32_16x16x32_bf16 v[52:55], v[44:47], v[36:39], v[52:55]
  v_perm_b32 v44, v133, v129, s31
  v_perm_b32 v45, v141, v137, s31
  v_perm_b32 v46, v149, v145, s31
  v_perm_b32 v47, v157, v153, s31
  v_mfma_f32_16x16x32_bf16 v[56:59], v[40:43], v[36:39], v[56:59]
  v_perm_b32 v40, v134, v130, s30
  v_perm_b32 v41, v142, v138, s30
  v_perm_b32 v42, v150, v146, s30
  v_perm_b32 v43, v158, v154, s30
  v_mfma_f32_16x16x32_bf16 v[60:63], v[44:47], v[36:39], v[60:63]
  v_perm_b32 v44, v134, v130, s31
  v_perm_b32 v45, v142, v138, s31
  v_perm_b32 v46, v150, v146, s31
  v_perm_b32 v47, v158, v154, s31
  v_mfma_f32_16x16x32_bf16 v[64:67], v[40:43], v[36:39], v[64:67]
  v_perm_b32 v40, v135, v131, s30
  v_perm_b32 v41, v143, v139, s30
  v_perm_b32 v42, v151, v147, s30
  v_perm_b32 v43, v159, v155, s30
  v_mfma_f32_16x16x32_bf16 v[68:71], v[44:47], v[36:39], v[68:71]
  v_perm_b32 v44, v135, v131, s31
  v_perm_b32 v45, v143, v139, s31
  v_perm_b32 v46, v151, v147, s31
  v_perm_b32 v47, v159, v155, s31
  v_mfma_f32_16x16x32_bf16 v[72:75], v[40:43], v[36:39], v[72:75]
  s_nop 0
  v_mfma_f32_16x16x32_bf16 v[76:79], v[44:47], v[36:39], v[76:79]
  buffer_load_dwordx4 v[128:131], v5, s[12:15], s24 offen offset:0 nt
  buffer_load_dwordx4 v[132:135], v5, s[12:15], s24 offen offset:256 nt
  buffer_load_dwordx4 v[136:139], v5, s[12:15], s24 offen offset:512 nt
  buffer_load_dwordx4 v[140:143], v5, s[12:15], s24 offen offset:768 nt
  buffer_load_dwordx4 v[144:147], v5, s[12:15], s25 offen offset:0 nt
  buffer_load_dwordx4 v[148:151], v5, s[12:15], s25 offen offset:256 nt
  buffer_load_dwordx4 v[152:155], v5, s[12:15], s25 offen offset:512 nt
  buffer_load_dwordx4 v[156:159], v5, s[12:15], s25 offen offset:768 nt
  s_add_u32 s24, s24, s35
  s_add_u32 s25, s25, s35
  s_sub_u32 s26, s26, 1
  s_cmp_lg_u32 s26, 0
  s_cbranch_scc1 L_sloop
  s_nop 7
  s_cmp_eq_u32 s27, 1
  s_cselect_b32 s4, 4096, 0
  s_cselect_b32 s5, 256, 0
  v_add_u32 v86, s4, v6
  v_add_u32 v87, s5, v7
  s_mov_b64 exec, s[36:37]
  ds_write_b128 v86, v[48:51] offset:2048
  ds_write_b128 v86, v[52:55] offset:2112
  ds_write_b128 v86, v[56:59] offset:2176
  ds_write_b128 v86, v[60:63] offset:2240
  ds_write_b128 v86, v[64:67] offset:2304
  ds_write_b128 v86, v[68:71] offset:2368
  ds_write_b128 v86, v[72:75] offset:2432
  ds_write_b128 v86, v[76:79] offset:2496
  ds_write_b32 v87, v81 offset:10240
  ds_write_b32 v87, v80 offset:10256
  s_mov_b64 exec, -1
  s_waitcnt lgkmcnt(0)
  s_cmp_eq_u32 s27, 0
  s_cbranch_scc0 L_se1
  s_barrier
  ds_read_b128 v[12:15], v9 offset:256
  ds_read_b128 v[16:19], v9 offset:320
  ds_read_b128 v[20:23], v9 offset:384
  ds_read_b128 v[24:27], v9 offset:448
  v_mov_b32 v48, 0
  v_mov_b32 v49, 0
  v_mov_b32 v50, 0
  v_mov_b32 v51, 0
  v_mov_b32 v52, 0
  v_mov_b32 v53, 0
  v_mov_b32 v54, 0
  v_mov_b32 v55, 0
  v_mov_b32 v56, 0
  v_mov_b32 v57, 0
  v_mov_b32 v58, 0
  v_mov_b32 v59, 0
  v_mov_b32 v60, 0
  v_mov_b32 v61, 0
  v_mov_b32 v62, 0
  v_mov_b32 v63, 0
  v_mov_b32 v64, 0
  v_mov_b32 v65, 0
  v_mov_b32 v66, 0
  v_mov_b32 v67, 0
  v_mov_b32 v68, 0
  v_mov_b32 v69, 0
  v_mov_b32 v70, 0
  v_mov_b32 v71, 0
  v_mov_b32 v72, 0
  v_mov_b32 v73, 0
  v_mov_b32 v74, 0
  v_mov_b32 v75, 0
  v_mov_b32 v76, 0
  v_mov_b32 v77, 0
  v_mov_b32 v78, 0
  v_mov_b32 v79, 0
  v_mov_b32 v80, 0xff800000
  v_mov_b32 v84, 0xff800000
  v_mov_b32 v81, 0
  s_mov_b32 s27, 1
  s_mov_b32 s26, 8
  s_waitcnt lgkmcnt(0)
  s_branch L_sloop
L_se1:
  s_cmp_eq_u32 s27, 1
  s_cbranch_scc0 L_se2
  s_barrier
  ds_read_b128 v[12:15], v8 offset:0
  ds_read_b128 v[16:19], v8 offset:64
  ds_read_b128 v[20:23], v8 offset:128
  ds_read_b128 v[24:27], v8 offset:192
  ds_read_b128 v[48:51], v6 offset:2048
  ds_read_b128 v[52:55], v6 offset:2112
  ds_read_b128 v[56:59], v6 offset:2176
  ds_read_b128 v[60:63], v6 offset:2240
  ds_read_b128 v[64:67], v6 offset:2304
  ds_read_b128 v[68:71], v6 offset:2368
  ds_read_b128 v[72:75], v6 offset:2432
  ds_read_b128 v[76:79], v6 offset:2496
  ds_read_b32 v81, v7 offset:10240
  ds_read_b32 v80, v7 offset:10256
  s_mov_b32 s27, 2
  s_mov_b32 s26, 20
  s_waitcnt lgkmcnt(0)
  v_mul_f32 v84, s29, v80
  s_branch L_sloop
L_se2:
  s_barrier
  s_waitcnt vmcnt(0)
  s_endpgm
L_H:
  s_mov_b32 s8, s70
  s_and_b32 s9, s71, 0xffff
  s_mov_b32 s10, 2621440
  s_mov_b32 s11, 0x20000
  s_mov_b32 s16, s44
  s_and_b32 s17, s45, 0xffff
  s_mov_b32 s18, 4096
  s_mov_b32 s19, 0x20000
  v_mov_b32 v6, 0x0
  buffer_load_dword v7, v6, s[8:11], 0 offen sc1
  s_and_b32 s34, s2, 31
  s_mov_b32 s28, 0x5040100
  s_mov_b32 s29, 0x7060302
  s_cmp_eq_u32 s3, 2
  s_cbranch_scc0 L_H1
  s_mov_b32 s12, s50
  s_and_b32 s13, s51, 0xffff
  s_mov_b32 s14, 4194304
  s_mov_b32 s15, 0x20000
  s_lshr_b32 s6, s2, 5
  v_and_b32 v6, 3, v3
  v_lshlrev_b32 v6, 10, v6
  v_lshl_add_u32 v6, v2, 4, v6
  v_lshlrev_b32 v5, 16, v2
  v_lshl_add_u32 v5, v3, 4, v5
  s_lshl_b32 s7, s6, 7
  s_lshl_b32 s31, s6, 19
  s_lshl_b32 s4, s34, 8
  s_add_u32 s31, s31, s4
  buffer_load_dwordx4 v[8:11], v6, s[16:19], s7 offen nt
  buffer_load_dwordx4 v[12:15], v6, s[16:19], s7 offen offset:64 nt
  buffer_load_dwordx4 v[24:27], v5, s[12:15], s31 offen nt
  s_add_u32 s31, s31, 8192
  buffer_load_dwordx4 v[28:31], v5, s[12:15], s31 offen nt
  s_add_u32 s31, s31, 8192
  buffer_load_dwordx4 v[32:35], v5, s[12:15], s31 offen nt
  s_add_u32 s31, s31, 8192
  buffer_load_dwordx4 v[36:39], v5, s[12:15], s31 offen nt
  s_add_u32 s31, s31, 8192
  buffer_load_dwordx4 v[40:43], v5, s[12:15], s31 offen nt
  s_add_u32 s31, s31, 8192
  buffer_load_dwordx4 v[44:47], v5, s[12:15], s31 offen nt
  s_add_u32 s31, s31, 8192
  buffer_load_dwordx4 v[48:51], v5, s[12:15], s31 offen nt
  s_add_u32 s31, s31, 8192
  buffer_load_dwordx4 v[52:55], v5, s[12:15], s31 offen nt
  s_add_u32 s31, s31, 204800
  buffer_load_dwordx4 v[56:59], v5, s[12:15], s31 offen nt
  s_add_u32 s31, s31, 8192
  buffer_load_dwordx4 v[60:63], v5, s[12:15], s31 offen nt
  s_add_u32 s31, s31, 8192
  buffer_load_dwordx4 v[64:67], v5, s[12:15], s31 offen nt
  s_add_u32 s31, s31, 8192
  buffer_load_dwordx4 v[68:71], v5, s[12:15], s31 offen nt
  s_add_u32 s31, s31, 8192
  buffer_load_dwordx4 v[72:75], v5, s[12:15], s31 offen nt
  s_add_u32 s31, s31, 8192
  buffer_load_dwordx4 v[76:79], v5, s[12:15], s31 offen nt
  s_add_u32 s31, s31, 8192
  buffer_load_dwordx4 v[80:83], v5, s[12:15], s31 offen nt
  s_add_u32 s31, s31, 8192
  buffer_load_dwordx4 v[84:87], v5, s[12:15], s31 offen nt
  s_barrier
  s_mov_b32 s22, 0xffff0000
  s_mov_b32 s23, 0
  s_mov_b32 s24, 0
  s_mov_b32 s25, 0x0000ffff
  s_mov_b32 s26, 0
  s_mov_b32 s27, 0xffff0000
  s_mov_b32 s30, 0x3fb8aa3b
  s_mov_b32 s39, 0xffff0000
  s_mov_b32 s32, 262144
  s_mov_b32 s88, 0x7060500
  s_mov_b32 s89, 0x7060501
  s_mov_b32 s90, 0x7060502
  s_mov_b32 s91, 0x7060503
  s_lshr_b32 s35, s2, 5
  s_and_b32 s36, s35, 1
  s_and_b32 s35, s35, 3
  s_lshr_b32 s37, s2, 6
  s_lshl_b32 s38, s34, 1
  s_add_u32 s38, s38, s36
  v_lshlrev_b32 v4, 4, v0
  v_mov_b32 v1, 0x80808080
  v_lshlrev_b32 v19, 9, v2
  v_lshl_add_u32 v19, v3, 4, v19
  s_lshl_b32 s7, s34, 3
  s_add_u32 s7, s7, s6
  s_lshl_b32 s7, s7, 11
  s_add_u32 s7, s7, 69632
  s_waitcnt vmcnt(8)
  v_perm_b32 v152, v28, v24, s28
  v_perm_b32 v153, v36, v32, s28
  v_perm_b32 v154, v44, v40, s28
  v_perm_b32 v155, v52, v48, s28
  v_perm_b32 v156, v28, v24, s29
  v_perm_b32 v157, v36, v32, s29
  v_perm_b32 v158, v44, v40, s29
  v_perm_b32 v159, v52, v48, s29
  v_mfma_f32_16x16x32_bf16 v[160:163], v[8:11], v[152:155], 0
  v_perm_b32 v152, v29, v25, s28
  v_perm_b32 v153, v37, v33, s28
  v_perm_b32 v154, v45, v41, s28
  v_perm_b32 v155, v53, v49, s28
  v_mfma_f32_16x16x32_bf16 v[164:167], v[8:11], v[156:159], 0
  v_perm_b32 v156, v29, v25, s29
  v_perm_b32 v157, v37, v33, s29
  v_perm_b32 v158, v45, v41, s29
  v_perm_b32 v159, v53, v49, s29
  v_mfma_f32_16x16x32_bf16 v[168:171], v[8:11], v[152:155], 0
  v_perm_b32 v152, v30, v26, s28
  v_perm_b32 v153, v38, v34, s28
  v_perm_b32 v154, v46, v42, s28
  v_perm_b32 v155, v54, v50, s28
  v_mfma_f32_16x16x32_bf16 v[172:175], v[8:11], v[156:159], 0
  v_perm_b32 v156, v30, v26, s29
  v_perm_b32 v157, v38, v34, s29
  v_perm_b32 v158, v46, v42, s29
  v_perm_b32 v159, v54, v50, s29
  v_mfma_f32_16x16x32_bf16 v[176:179], v[8:11], v[152:155], 0
  v_perm_b32 v152, v31, v27, s28
  v_perm_b32 v153, v39, v35, s28
  v_perm_b32 v154, v47, v43, s28
  v_perm_b32 v155, v55, v51, s28
  v_mfma_f32_16x16x32_bf16 v[180:183], v[8:11], v[156:159], 0
  v_perm_b32 v156, v31, v27, s29
  v_perm_b32 v157, v39, v35, s29
  v_perm_b32 v158, v47, v43, s29
  v_perm_b32 v159, v55, v51, s29
  v_mfma_f32_16x16x32_bf16 v[184:187], v[8:11], v[152:155], 0
  s_nop 0
  v_mfma_f32_16x16x32_bf16 v[188:191], v[8:11], v[156:159], 0
  s_waitcnt vmcnt(0)
  v_perm_b32 v152, v60, v56, s28
  v_perm_b32 v153, v68, v64, s28
  v_perm_b32 v154, v76, v72, s28
  v_perm_b32 v155, v84, v80, s28
  v_perm_b32 v156, v60, v56, s29
  v_perm_b32 v157, v68, v64, s29
  v_perm_b32 v158, v76, v72, s29
  v_perm_b32 v159, v84, v80, s29
  v_mfma_f32_16x16x32_bf16 v[160:163], v[12:15], v[152:155], v[160:163]
  v_perm_b32 v152, v61, v57, s28
  v_perm_b32 v153, v69, v65, s28
  v_perm_b32 v154, v77, v73, s28
  v_perm_b32 v155, v85, v81, s28
  v_mfma_f32_16x16x32_bf16 v[164:167], v[12:15], v[156:159], v[164:167]
  v_perm_b32 v156, v61, v57, s29
  v_perm_b32 v157, v69, v65, s29
  v_perm_b32 v158, v77, v73, s29
  v_perm_b32 v159, v85, v81, s29
  v_mfma_f32_16x16x32_bf16 v[168:171], v[12:15], v[152:155], v[168:171]
  v_perm_b32 v152, v62, v58, s28
  v_perm_b32 v153, v70, v66, s28
  v_perm_b32 v154, v78, v74, s28
  v_perm_b32 v155, v86, v82, s28
  v_mfma_f32_16x16x32_bf16 v[172:175], v[12:15], v[156:159], v[172:175]
  v_perm_b32 v156, v62, v58, s29
  v_perm_b32 v157, v70, v66, s29
  v_perm_b32 v158, v78, v74, s29
  v_perm_b32 v159, v86, v82, s29
  v_mfma_f32_16x16x32_bf16 v[176:179], v[12:15], v[152:155], v[176:179]
  v_perm_b32 v152, v63, v59, s28
  v_perm_b32 v153, v71, v67, s28
  v_perm_b32 v154, v79, v75, s28
  v_perm_b32 v155, v87, v83, s28
  v_mfma_f32_16x16x32_bf16 v[180:183], v[12:15], v[156:159], v[180:183]
  v_perm_b32 v156, v63, v59, s29
  v_perm_b32 v157, v71, v67, s29
  v_perm_b32 v158, v79, v75, s29
  v_perm_b32 v159, v87, v83, s29
  v_mfma_f32_16x16x32_bf16 v[184:187], v[12:15], v[152:155], v[184:187]
  s_nop 0
  v_mfma_f32_16x16x32_bf16 v[188:191], v[12:15], v[156:159], v[188:191]
  v_readfirstlane_b32 s20, v7
  s_nop 3
  s_add_u32 s20, s20, 0x9e3779b9
  s_bfe_u32 s84, s20, 0x80000
  s_bfe_u32 s85, s20, 0x80008
  s_bfe_u32 s86, s20, 0x80010
  s_bfe_u32 s87, s20, 0x80018
  v_mov_b32 v16, s20
  v_cndmask_b32 v24, v160, v161, s[22:23]
  v_cndmask_b32 v25, v164, v165, s[22:23]
  v_cndmask_b32 v26, v168, v169, s[22:23]
  v_cndmask_b32 v27, v172, v173, s[22:23]
  v_cndmask_b32 v28, v176, v177, s[22:23]
  v_cndmask_b32 v29, v180, v181, s[22:23]
  v_cndmask_b32 v30, v184, v185, s[22:23]
  v_cndmask_b32 v31, v188, v189, s[22:23]
  v_cndmask_b32 v24, v24, v162, s[24:25]
  v_cndmask_b32 v25, v25, v166, s[24:25]
  v_cndmask_b32 v26, v26, v170, s[24:25]
  v_cndmask_b32 v27, v27, v174, s[24:25]
  v_cndmask_b32 v28, v28, v178, s[24:25]
  v_cndmask_b32 v29, v29, v182, s[24:25]
  v_cndmask_b32 v30, v30, v186, s[24:25]
  v_cndmask_b32 v31, v31, v190, s[24:25]
  v_cndmask_b32 v24, v24, v163, s[26:27]
  v_cndmask_b32 v25, v25, v167, s[26:27]
  v_cndmask_b32 v26, v26, v171, s[26:27]
  v_cndmask_b32 v27, v27, v175, s[26:27]
  v_cndmask_b32 v28, v28, v179, s[26:27]
  v_cndmask_b32 v29, v29, v183, s[26:27]
  v_cndmask_b32 v30, v30, v187, s[26:27]
  v_cndmask_b32 v31, v31, v191, s[26:27]
  v_perm_b32 v24, v24, v16, s88
  v_perm_b32 v25, v25, v16, s89
  v_perm_b32 v26, v26, v16, s90
  v_perm_b32 v27, v27, v16, s91
  buffer_store_dwordx4 v[24:27], v19, s[8:11], s7 offen offset:0 sc1
  v_perm_b32 v28, v28, v16, s88
  v_perm_b32 v29, v29, v16, s89
  v_perm_b32 v30, v30, v16, s90
  v_perm_b32 v31, v31, v16, s91
  buffer_store_dwordx4 v[28:31], v19, s[8:11], s7 offen offset:256 sc1
  v_lshrrev_b32 v6, 5, v0
  v_lshlrev_b32 v6, 11, v6
  v_and_b32 v7, 31, v0
  v_lshl_add_u32 v6, v7, 4, v6
  s_lshl_b32 s4, s34, 14
  s_lshl_b32 s5, s35, 9
  s_add_u32 s4, s4, s5
  s_add_u32 s4, s4, 69632
  s_add_u32 s5, s4, 4096
  s_add_u32 s6, s4, 8192
  s_add_u32 s7, s4, 12288
  s_waitcnt vmcnt(0)
  buffer_load_dwordx4 v[24:27], v6, s[8:11], s4 offen sc1
  buffer_load_dwordx4 v[28:31], v6, s[8:11], s5 offen sc1
  buffer_load_dwordx4 v[32:35], v6, s[8:11], s6 offen sc1
  buffer_load_dwordx4 v[36:39], v6, s[8:11], s7 offen sc1
  s_barrier
  s_branch L_qa_first
L_qa_retry:
  buffer_load_dwordx4 v[24:27], v6, s[8:11], s4 offen sc1
  buffer_load_dwordx4 v[28:31], v6, s[8:11], s5 offen sc1
  buffer_load_dwordx4 v[32:35], v6, s[8:11], s6 offen sc1
  buffer_load_dwordx4 v[36:39], v6, s[8:11], s7 offen sc1
L_qa_first:
  s_waitcnt vmcnt(0)
  v_xor_b32 v152, s84, v24
  v_bitop3_b32 v152, v152, v25, s85 bitop3:0xf6
  v_bitop3_b32 v152, v152, v26, s86 bitop3:0xf6
  v_bitop3_b32 v152, v152, v27, s87 bitop3:0xf6
  v_bitop3_b32 v152, v152, v28, s84 bitop3:0xf6
  v_bitop3_b32 v152, v152, v29, s85 bitop3:0xf6
  v_bitop3_b32 v152, v152, v30, s86 bitop3:0xf6
  v_bitop3_b32 v152, v152, v31, s87 bitop3:0xf6
  v_bitop3_b32 v152, v152, v32, s84 bitop3:0xf6
  v_bitop3_b32 v152, v152, v33, s85 bitop3:0xf6
  v_bitop3_b32 v152, v152, v34, s86 bitop3:0xf6
  v_bitop3_b32 v152, v152, v35, s87 bitop3:0xf6
  v_bitop3_b32 v152, v152, v36, s84 bitop3:0xf6
  v_bitop3_b32 v152, v152, v37, s85 bitop3:0xf6
  v_bitop3_b32 v152, v152, v38, s86 bitop3:0xf6
  v_bitop3_b32 v152, v152, v39, s87 bitop3:0xf6
  v_and_b32 v152, 0xff, v152
  v_cmp_ne_u32 vcc, 0, v152
  s_cbranch_vccz L_ok_3
  s_sub_u32 s32, s32, 1
  s_cmp_eq_u32 s32, 0
  s_cbranch_scc1 L_ok_3
  s_branch L_qa_retry
L_ok_3:
  s_mov_b32 s12, s52
  s_and_b32 s13, s53, 0xffff
  s_mov_b32 s14, 4194304
  s_mov_b32 s15, 0x20000
  v_lshlrev_b32 v5, 10, v2
  v_lshl_add_u32 v5, v3, 4, v5
  s_lshl_b32 s92, s34, 17
  s_lshl_b32 s93, s36, 16
  s_add_u32 s92, s92, s93
  s_lshl_b32 s93, s37, 8
  s_add_u32 s92, s92, s93
  s_add_u32 s31, s92, 0
  buffer_load_dwordx4 v[56:59], v5, s[12:15], s31 offen nt
  s_add_u32 s31, s92, 8192
  buffer_load_dwordx4 v[60:63], v5, s[12:15], s31 offen nt
  s_add_u32 s31, s92, 16384
  buffer_load_dwordx4 v[64:67], v5, s[12:15], s31 offen nt
  s_add_u32 s31, s92, 24576
  buffer_load_dwordx4 v[68:71], v5, s[12:15], s31 offen nt
  s_add_u32 s31, s92, 32768
  buffer_load_dwordx4 v[72:75], v5, s[12:15], s31 offen nt
  s_add_u32 s31, s92, 40960
  buffer_load_dwordx4 v[76:79], v5, s[12:15], s31 offen nt
  s_add_u32 s31, s92, 49152
  buffer_load_dwordx4 v[80:83], v5, s[12:15], s31 offen nt
  s_add_u32 s31, s92, 57344
  buffer_load_dwordx4 v[84:87], v5, s[12:15], s31 offen nt
  s_add_u32 s31, s92, 4096
  buffer_load_dwordx4 v[88:91], v5, s[12:15], s31 offen nt
  s_add_u32 s31, s92, 12288
  buffer_load_dwordx4 v[92:95], v5, s[12:15], s31 offen nt
  s_add_u32 s31, s92, 20480
  buffer_load_dwordx4 v[96:99], v5, s[12:15], s31 offen nt
  s_add_u32 s31, s92, 28672
  buffer_load_dwordx4 v[100:103], v5, s[12:15], s31 offen nt
  s_add_u32 s31, s92, 36864
  buffer_load_dwordx4 v[104:107], v5, s[12:15], s31 offen nt
  s_add_u32 s31, s92, 45056
  buffer_load_dwordx4 v[108:111], v5, s[12:15], s31 offen nt
  s_add_u32 s31, s92, 53248
  buffer_load_dwordx4 v[112:115], v5, s[12:15], s31 offen nt
  s_add_u32 s31, s92, 61440
  buffer_load_dwordx4 v[116:119], v5, s[12:15], s31 offen nt
  s_barrier
  v_perm_b32 v24, v24, v1, s88
  v_perm_b32 v25, v25, v1, s88
  v_perm_b32 v26, v26, v1, s88
  v_perm_b32 v27, v27, v1, s88
  v_perm_b32 v28, v28, v1, s88
  v_perm_b32 v29, v29, v1, s88
  v_perm_b32 v30, v30, v1, s88
  v_perm_b32 v31, v31, v1, s88
  v_perm_b32 v32, v32, v1, s88
  v_perm_b32 v33, v33, v1, s88
  v_perm_b32 v34, v34, v1, s88
  v_perm_b32 v35, v35, v1, s88
  v_perm_b32 v36, v36, v1, s88
  v_perm_b32 v37, v37, v1, s88
  v_perm_b32 v38, v38, v1, s88
  v_perm_b32 v39, v39, v1, s88
  v_add_f32 v24, v24, v28
  v_add_f32 v32, v32, v36
  v_add_f32 v25, v25, v29
  v_add_f32 v33, v33, v37
  v_add_f32 v26, v26, v30
  v_add_f32 v34, v34, v38
  v_add_f32 v27, v27, v31
  v_add_f32 v35, v35, v39
  v_add_f32 v24, v24, v32
  v_add_f32 v25, v25, v33
  v_add_f32 v26, v26, v34
  v_add_f32 v27, v27, v35
  v_mov_b32 v28, v24
  v_mov_b32 v29, v25
  v_mov_b32 v30, v26
  v_mov_b32 v31, v27
  v_permlane32_swap_b32 v24, v28
  v_permlane32_swap_b32 v25, v29
  v_permlane32_swap_b32 v26, v30
  v_permlane32_swap_b32 v27, v31
  v_add_f32 v24, v24, v28
  v_add_f32 v25, v25, v29
  v_add_f32 v26, v26, v30
  v_add_f32 v27, v27, v31
  v_lshlrev_b32 v6, 4, v3
  v_bfe_u32 v7, v0, 4, 1
  v_lshl_add_u32 v6, v7, 3, v6
  v_cvt_pk_bf16_f32 v24, v24, v25
  v_cvt_pk_bf16_f32 v25, v26, v27
  ds_write_b64 v6, v[24:25] offset:0
  s_waitcnt lgkmcnt(0)
  s_barrier
  s_waitcnt vmcnt(8)
  v_perm_b32 v192, v60, v56, s28
  v_perm_b32 v193, v68, v64, s28
  v_perm_b32 v194, v76, v72, s28
  v_perm_b32 v195, v84, v80, s28
  v_perm_b32 v196, v60, v56, s29
  v_perm_b32 v197, v68, v64, s29
  v_perm_b32 v198, v76, v72, s29
  v_perm_b32 v199, v84, v80, s29
  v_perm_b32 v200, v61, v57, s28
  v_perm_b32 v201, v69, v65, s28
  v_perm_b32 v202, v77, v73, s28
  v_perm_b32 v203, v85, v81, s28
  v_perm_b32 v204, v61, v57, s29
  v_perm_b32 v205, v69, v65, s29
  v_perm_b32 v206, v77, v73, s29
  v_perm_b32 v207, v85, v81, s29
  v_perm_b32 v208, v62, v58, s28
  v_perm_b32 v209, v70, v66, s28
  v_perm_b32 v210, v78, v74, s28
  v_perm_b32 v211, v86, v82, s28
  v_perm_b32 v212, v62, v58, s29
  v_perm_b32 v213, v70, v66, s29
  v_perm_b32 v214, v78, v74, s29
  v_perm_b32 v215, v86, v82, s29
  v_perm_b32 v216, v63, v59, s28
  v_perm_b32 v217, v71, v67, s28
  v_perm_b32 v218, v79, v75, s28
  v_perm_b32 v219, v87, v83, s28
  v_perm_b32 v220, v63, v59, s29
  v_perm_b32 v221, v71, v67, s29
  v_perm_b32 v222, v79, v75, s29
  v_perm_b32 v223, v87, v83, s29
  s_waitcnt vmcnt(0)
  v_perm_b32 v224, v92, v88, s28
  v_perm_b32 v225, v100, v96, s28
  v_perm_b32 v226, v108, v104, s28
  v_perm_b32 v227, v116, v112, s28
  v_perm_b32 v228, v92, v88, s29
  v_perm_b32 v229, v100, v96, s29
  v_perm_b32 v230, v108, v104, s29
  v_perm_b32 v231, v116, v112, s29
  v_perm_b32 v232, v93, v89, s28
  v_perm_b32 v233, v101, v97, s28
  v_perm_b32 v234, v109, v105, s28
  v_perm_b32 v235, v117, v113, s28
  v_perm_b32 v236, v93, v89, s29
  v_perm_b32 v237, v101, v97, s29
  v_perm_b32 v238, v109, v105, s29
  v_perm_b32 v239, v117, v113, s29
  v_perm_b32 v240, v94, v90, s28
  v_perm_b32 v241, v102, v98, s28
  v_perm_b32 v242, v110, v106, s28
  v_perm_b32 v243, v118, v114, s28
  v_perm_b32 v244, v94, v90, s29
  v_perm_b32 v245, v102, v98, s29
  v_perm_b32 v246, v110, v106, s29
  v_perm_b32 v247, v118, v114, s29
  v_perm_b32 v248, v95, v91, s28
  v_perm_b32 v249, v103, v99, s28
  v_perm_b32 v250, v111, v107, s28
  v_perm_b32 v251, v119, v115, s28
  v_perm_b32 v252, v95, v91, s29
  v_perm_b32 v253, v103, v99, s29
  v_perm_b32 v254, v111, v107, s29
  v_perm_b32 v255, v119, v115, s29
  v_bfe_u32 v152, v0, 1, 1
  v_lshlrev_b32 v17, 8, v152
  v_bfe_u32 v152, v0, 2, 3
  v_lshl_add_u32 v17, v152, 5, v17
  v_and_b32 v152, 1, v0
  v_lshl_add_u32 v17, v152, 4, v17
  v_lshrrev_b32 v152, 5, v0
  v_and_b32 v153, 31, v0
  v_lshlrev_b32 v20, 4, v153
  v_mov_b32 v21, 0
  v_mul_u32_u24 v8, 32768, v2
  v_lshl_add_u32 v8, v3, 4, v8
  v_lshlrev_b32 v9, 13, v2
  v_and_b32 v152, 1, v3
  v_lshl_add_u32 v9, v152, 7, v9
  s_mul_i32 s42, s34, 1024
  s_lshl_b32 s5, s36, 8
  s_add_u32 s42, s42, s5
  s_add_u32 s42, s42, 1183744
  s_lshl_b32 s43, s34, 8
  s_add_u32 s43, s43, 36864
  s_lshr_b32 s5, s2, 7
  s_lshl_b32 s6, s35, 5
  s_add_u32 s6, s6, s34
  s_lshl_b32 s6, s6, 1
  s_add_u32 s6, s6, s5
  s_lshl_b32 s40, s6, 9
  s_add_u32 s40, s40, 1183744
  s_lshl_b32 s41, s6, 7
  s_add_u32 s41, s41, 36864
  s_barrier
  s_barrier
  v_lshlrev_b32 v6, 3, v2
  ds_read_b32 v18, v6 offset:11776
  s_waitcnt lgkmcnt(0)
  s_barrier
  s_barrier
  s_barrier
L_tail_h0:
  ds_read_b128 v[32:35], v20 offset:2048
  ds_read_b128 v[40:43], v21 offset:10240
  ds_read_b32 v48, v21 offset:10256
  ds_read_b128 v[36:39], v20 offset:4096
  ds_read_b128 v[44:47], v21 offset:10368
  ds_read_b32 v49, v21 offset:10384
  s_waitcnt lgkmcnt(0)
  v_max_f32 v28, v48, v49
  v_sub_f32 v50, v48, v28
  v_sub_f32 v51, v49, v28
  v_mul_f32 v50, s30, v50
  v_mul_f32 v51, s30, v51
  v_exp_f32 v50, v50
  v_exp_f32 v51, v51
  v_add_f32 v40, v40, v41
  v_add_f32 v42, v42, v43
  v_add_f32 v44, v44, v45
  v_add_f32 v46, v46, v47
  v_mul_f32 v24, v50, v32
  v_mul_f32 v25, v50, v33
  v_mul_f32 v26, v50, v34
  v_mul_f32 v27, v50, v35
  v_fmac_f32 v24, v51, v36
  v_fmac_f32 v25, v51, v37
  v_fmac_f32 v26, v51, v38
  v_fmac_f32 v27, v51, v39
  v_perm_b32 v24, v24, v16, s88
  v_perm_b32 v25, v25, v16, s89
  v_perm_b32 v26, v26, v16, s90
  v_perm_b32 v27, v27, v16, s91
  s_mov_b32 exec_hi, 0
  buffer_store_dwordx4 v[24:27], v17, s[8:11], s40 offen sc1
  s_mov_b64 exec, -1
  v_add_f32 v40, v40, v42
  v_add_f32 v44, v44, v46
  v_mov_b32 v29, s20
  v_mul_f32 v30, v50, v40
  v_mov_b32 v31, s20
  v_fmac_f32 v30, v51, v44
  s_mov_b64 exec, 0xff
  buffer_store_dwordx4 v[28:31], v4, s[8:11], s41 offen sc1
  s_mov_b64 exec, -1
L_st2a_g:
  buffer_load_dwordx4 v[32:35], v9, s[8:11], s43 offen sc1
  buffer_load_dwordx4 v[24:27], v8, s[8:11], s42 offen offset:0 sc1
  buffer_load_dwordx4 v[28:31], v8, s[8:11], s42 offen offset:512 sc1
  s_waitcnt vmcnt(0)
  v_xor_b32 v152, s84, v24
  v_bitop3_b32 v152, v152, v25, s85 bitop3:0xf6
  v_bitop3_b32 v152, v152, v26, s86 bitop3:0xf6
  v_bitop3_b32 v152, v152, v27, s87 bitop3:0xf6
  v_bitop3_b32 v152, v152, v28, s84 bitop3:0xf6
  v_bitop3_b32 v152, v152, v29, s85 bitop3:0xf6
  v_bitop3_b32 v152, v152, v30, s86 bitop3:0xf6
  v_bitop3_b32 v152, v152, v31, s87 bitop3:0xf6
  v_and_b32 v152, 0xff, v152
  v_bitop3_b32 v152, v152, v33, s20 bitop3:0xf6
  v_bitop3_b32 v152, v152, v35, s20 bitop3:0xf6
  v_cmp_ne_u32 vcc, 0, v152
  s_cbranch_vccz L_ok_4
  s_sub_u32 s32, s32, 1
  s_cmp_eq_u32 s32, 0
  s_cbranch_scc1 L_ok_4
  s_branch L_st2a_g
L_ok_4:
  v_mov_b32 v154, v32
  v_perm_b32 v24, v24, v1, s88
  v_perm_b32 v25, v25, v1, s88
  v_max_f32_dpp v154, v154, v154 quad_perm:[1,0,3,2] row_mask:0xf bank_mask:0xf
  v_sub_f32 v155, v32, v154
  v_mul_f32 v155, s30, v155
  v_exp_f32 v155, v155
  v_lshlrev_b32 v6, 3, v0
  v_mul_f32 v156, v155, v34
  v_perm_b32 v26, v26, v1, s88
  v_perm_b32 v27, v27, v1, s88
  v_add_f32_dpp v156, v156, v156 quad_perm:[1,0,3,2] row_mask:0xf bank_mask:0xf
  v_rcp_f32 v156, v156
  v_perm_b32 v28, v28, v1, s88
  v_perm_b32 v29, v29, v1, s88
  v_perm_b32 v30, v30, v1, s88
  v_perm_b32 v31, v31, v1, s88
  v_mul_f32 v155, v18, v155
  v_and_b32 v7, 3, v3
  v_mul_f32 v155, v155, v156
  v_lshlrev_b32 v7, 7, v7
  v_lshl_add_u32 v7, v2, 4, v7
  v_mul_f32_dpp v156, v155, v24 row_newbcast:0 row_mask:0xf bank_mask:0xf
  v_mul_f32_dpp v157, v155, v25 row_newbcast:0 row_mask:0xf bank_mask:0xf
  v_mul_f32_dpp v158, v155, v26 row_newbcast:0 row_mask:0xf bank_mask:0xf
  v_mul_f32_dpp v159, v155, v27 row_newbcast:0 row_mask:0xf bank_mask:0xf
  v_fmac_f32_dpp v156, v155, v28 row_newbcast:1 row_mask:0xf bank_mask:0xf
  v_fmac_f32_dpp v157, v155, v29 row_newbcast:1 row_mask:0xf bank_mask:0xf
  v_fmac_f32_dpp v158, v155, v30 row_newbcast:1 row_mask:0xf bank_mask:0xf
  v_fmac_f32_dpp v159, v155, v31 row_newbcast:1 row_mask:0xf bank_mask:0xf
  v_cvt_pk_bf16_f32 v156, v156, v157
  v_cvt_pk_bf16_f32 v157, v158, v159
  ds_write_b64 v6, v[156:157] offset:10752
  s_waitcnt lgkmcnt(0)
  ds_read_b128 v[8:11], v7 offset:10752
  ds_read_b128 v[12:15], v7 offset:10816
  s_waitcnt lgkmcnt(0)
  v_mfma_f32_16x16x32_bf16 v[160:163], v[8:11], v[192:195], 0
  v_mfma_f32_16x16x32_bf16 v[164:167], v[8:11], v[196:199], 0
  v_mfma_f32_16x16x32_bf16 v[168:171], v[8:11], v[200:203], 0
  v_mfma_f32_16x16x32_bf16 v[172:175], v[8:11], v[204:207], 0
  v_mfma_f32_16x16x32_bf16 v[176:179], v[8:11], v[208:211], 0
  v_mfma_f32_16x16x32_bf16 v[180:183], v[8:11], v[212:215], 0
  v_mfma_f32_16x16x32_bf16 v[184:187], v[8:11], v[216:219], 0
  v_mfma_f32_16x16x32_bf16 v[188:191], v[8:11], v[220:223], 0
  v_mfma_f32_16x16x32_bf16 v[160:163], v[12:15], v[224:227], v[160:163]
  v_mfma_f32_16x16x32_bf16 v[164:167], v[12:15], v[228:231], v[164:167]
  v_mfma_f32_16x16x32_bf16 v[168:171], v[12:15], v[232:235], v[168:171]
  v_mfma_f32_16x16x32_bf16 v[172:175], v[12:15], v[236:239], v[172:175]
  v_mfma_f32_16x16x32_bf16 v[176:179], v[12:15], v[240:243], v[176:179]
  v_mfma_f32_16x16x32_bf16 v[180:183], v[12:15], v[244:247], v[180:183]
  v_mfma_f32_16x16x32_bf16 v[184:187], v[12:15], v[248:251], v[184:187]
  v_mfma_f32_16x16x32_bf16 v[188:191], v[12:15], v[252:255], v[188:191]
  s_lshl_b32 s4, s37, 6
  s_add_u32 s4, s4, s38
  s_lshl_b32 s4, s4, 11
  s_add_u32 s4, s4, 1839104
  v_lshlrev_b32 v6, 5, v0
  s_barrier
  ds_read_b128 v[32:35], v6 offset:11840
  ds_read_b128 v[36:39], v6 offset:11856
  s_nop 3
  v_cndmask_b32 v24, v160, v161, s[22:23]
  v_cndmask_b32 v25, v164, v165, s[22:23]
  v_cndmask_b32 v26, v168, v169, s[22:23]
  v_cndmask_b32 v27, v172, v173, s[22:23]
  v_cndmask_b32 v28, v176, v177, s[22:23]
  v_cndmask_b32 v29, v180, v181, s[22:23]
  v_cndmask_b32 v30, v184, v185, s[22:23]
  v_cndmask_b32 v31, v188, v189, s[22:23]
  v_cndmask_b32 v24, v24, v162, s[24:25]
  v_cndmask_b32 v25, v25, v166, s[24:25]
  v_cndmask_b32 v26, v26, v170, s[24:25]
  v_cndmask_b32 v27, v27, v174, s[24:25]
  v_cndmask_b32 v28, v28, v178, s[24:25]
  v_cndmask_b32 v29, v29, v182, s[24:25]
  v_cndmask_b32 v30, v30, v186, s[24:25]
  v_cndmask_b32 v31, v31, v190, s[24:25]
  v_cndmask_b32 v24, v24, v163, s[26:27]
  v_cndmask_b32 v25, v25, v167, s[26:27]
  v_cndmask_b32 v26, v26, v171, s[26:27]
  v_cndmask_b32 v27, v27, v175, s[26:27]
  v_cndmask_b32 v28, v28, v179, s[26:27]
  v_cndmask_b32 v29, v29, v183, s[26:27]
  v_cndmask_b32 v30, v30, v187, s[26:27]
  v_cndmask_b32 v31, v31, v191, s[26:27]
  s_waitcnt lgkmcnt(0)
  v_add_f32 v24, v24, v32
  v_add_f32 v25, v25, v33
  v_add_f32 v26, v26, v34
  v_add_f32 v27, v27, v35
  v_perm_b32 v24, v24, v16, s88
  v_perm_b32 v25, v25, v16, s89
  v_perm_b32 v26, v26, v16, s90
  v_perm_b32 v27, v27, v16, s91
  buffer_store_dwordx4 v[24:27], v19, s[8:11], s4 offen offset:0 sc1
  v_add_f32 v28, v28, v36
  v_add_f32 v29, v29, v37
  v_add_f32 v30, v30, v38
  v_add_f32 v31, v31, v39
  v_perm_b32 v28, v28, v16, s88
  v_perm_b32 v29, v29, v16, s89
  v_perm_b32 v30, v30, v16, s90
  v_perm_b32 v31, v31, v16, s91
  buffer_store_dwordx4 v[28:31], v19, s[8:11], s4 offen offset:256 sc1
  v_lshrrev_b32 v6, 1, v0
  v_lshlrev_b32 v6, 11, v6
  v_and_b32 v7, 1, v0
  v_lshl_add_u32 v6, v7, 4, v6
  s_bfe_u32 s4, s2, 0x20004
  s_lshl_b32 s4, s4, 17
  s_lshr_b32 s5, s2, 6
  s_lshl_b32 s5, s5, 9
  s_add_u32 s4, s4, s5
  s_bfe_u32 s5, s2, 0x10003
  s_lshl_b32 s5, s5, 8
  s_add_u32 s4, s4, s5
  s_and_b32 s5, s2, 7
  s_lshl_b32 s5, s5, 5
  s_add_u32 s4, s4, s5
  s_add_u32 s4, s4, 1839104
  s_add_u32 s5, s4, 65536
L_fin:
  buffer_load_dwordx4 v[40:43], v6, s[8:11], s4 offen sc1
  buffer_load_dwordx4 v[44:47], v6, s[8:11], s5 offen sc1
  s_lshr_b32 s6, s2, 6
  s_lshl_b32 s6, s6, 10
  s_bfe_u32 s7, s2, 0x20004
  s_lshl_b32 s7, s7, 8
  s_add_u32 s6, s6, s7
  s_and_b32 s7, s2, 7
  s_lshl_b32 s7, s7, 5
  s_add_u32 s6, s6, s7
  s_bfe_u32 s7, s2, 0x10003
  s_lshl_b32 s7, s7, 3
  s_add_u32 s6, s6, s7
  s_mov_b32 s12, s66
  s_and_b32 s13, s67, 0xffff
  s_mov_b32 s14, 4096
  s_mov_b32 s15, 0x20000
  s_waitcnt vmcnt(0)
  v_xor_b32 v152, s84, v40
  v_bitop3_b32 v152, v152, v41, s85 bitop3:0xf6
  v_bitop3_b32 v152, v152, v42, s86 bitop3:0xf6
  v_bitop3_b32 v152, v152, v43, s87 bitop3:0xf6
  v_bitop3_b32 v152, v152, v44, s84 bitop3:0xf6
  v_bitop3_b32 v152, v152, v45, s85 bitop3:0xf6
  v_bitop3_b32 v152, v152, v46, s86 bitop3:0xf6
  v_bitop3_b32 v152, v152, v47, s87 bitop3:0xf6
  v_and_b32 v152, 0xff, v152
  v_cmp_ne_u32 vcc, 0, v152
  s_cbranch_vccz L_ok_5
  s_sub_u32 s32, s32, 1
  s_cmp_eq_u32 s32, 0
  s_cbranch_scc1 L_ok_5
  s_branch L_fin
L_ok_5:
  v_perm_b32 v40, v40, v1, s88
  v_perm_b32 v41, v41, v1, s88
  v_perm_b32 v42, v42, v1, s88
  v_perm_b32 v43, v43, v1, s88
  v_perm_b32 v44, v44, v1, s88
  v_perm_b32 v45, v45, v1, s88
  v_perm_b32 v46, v46, v1, s88
  v_perm_b32 v47, v47, v1, s88
  v_add_f32 v40, v40, v44
  v_add_f32 v41, v41, v45
  v_add_f32 v42, v42, v46
  v_add_f32 v43, v43, v47
  v_add_f32_dpp v40, v40, v40 quad_perm:[2,3,0,1] row_mask:0xf bank_mask:0xf
  v_add_f32_dpp v41, v41, v41 quad_perm:[2,3,0,1] row_mask:0xf bank_mask:0xf
  v_add_f32_dpp v42, v42, v42 quad_perm:[2,3,0,1] row_mask:0xf bank_mask:0xf
  v_add_f32_dpp v43, v43, v43 quad_perm:[2,3,0,1] row_mask:0xf bank_mask:0xf
  v_add_f32_dpp v40, v40, v40 row_ror:4 row_mask:0xf bank_mask:0xf
  v_add_f32_dpp v41, v41, v41 row_ror:4 row_mask:0xf bank_mask:0xf
  v_add_f32_dpp v42, v42, v42 row_ror:4 row_mask:0xf bank_mask:0xf
  v_add_f32_dpp v43, v43, v43 row_ror:4 row_mask:0xf bank_mask:0xf
  v_add_f32_dpp v40, v40, v40 row_ror:8 row_mask:0xf bank_mask:0xf
  v_add_f32_dpp v41, v41, v41 row_ror:8 row_mask:0xf bank_mask:0xf
  v_add_f32_dpp v42, v42, v42 row_ror:8 row_mask:0xf bank_mask:0xf
  v_add_f32_dpp v43, v43, v43 row_ror:8 row_mask:0xf bank_mask:0xf
  v_mov_b32 v44, v40
  v_mov_b32 v45, v41
  v_mov_b32 v46, v42
  v_mov_b32 v47, v43
  v_permlane16_swap_b32 v40, v44
  v_permlane16_swap_b32 v41, v45
  v_permlane16_swap_b32 v42, v46
  v_permlane16_swap_b32 v43, v47
  v_add_f32 v40, v40, v44
  v_add_f32 v41, v41, v45
  v_add_f32 v42, v42, v46
  v_add_f32 v43, v43, v47
  v_mov_b32 v44, v40
  v_mov_b32 v45, v41
  v_mov_b32 v46, v42
  v_mov_b32 v47, v43
  v_permlane32_swap_b32 v40, v44
  v_permlane32_swap_b32 v41, v45
  v_permlane32_swap_b32 v42, v46
  v_permlane32_swap_b32 v43, v47
  v_add_f32 v40, v40, v44
  v_add_f32 v41, v41, v45
  v_add_f32 v42, v42, v46
  v_add_f32 v43, v43, v47
  v_lshlrev_b32 v6, 4, v7
  v_cvt_pk_bf16_f32 v40, v40, v41
  v_cvt_pk_bf16_f32 v41, v42, v43
  s_mov_b64 exec, 3
  buffer_store_dwordx2 v[40:41], v6, s[12:15], s6 offen sc1
  s_cmp_eq_u32 s2, 0
  s_cbranch_scc0 L_noep
  s_mov_b64 exec, 1
  v_mov_b32 v6, 0x0
  buffer_store_dword v16, v6, s[8:11], 0 offen sc1
L_noep:
  s_mov_b64 exec, -1
  s_branch L_hend
L_H1:
  s_barrier
  s_mov_b32 s22, 0xffff0000
  s_mov_b32 s23, 0
  s_mov_b32 s24, 0
  s_mov_b32 s25, 0x0000ffff
  s_mov_b32 s26, 0
  s_mov_b32 s27, 0xffff0000
  s_mov_b32 s30, 0x3fb8aa3b
  s_mov_b32 s39, 0xffff0000
  s_mov_b32 s32, 262144
  s_mov_b32 s88, 0x7060500
  s_mov_b32 s89, 0x7060501
  s_mov_b32 s90, 0x7060502
  s_mov_b32 s91, 0x7060503
  s_lshr_b32 s35, s2, 5
  s_and_b32 s36, s35, 1
  s_and_b32 s35, s35, 3
  s_lshr_b32 s37, s2, 6
  s_lshl_b32 s38, s34, 1
  s_add_u32 s38, s38, s36
  v_lshlrev_b32 v4, 4, v0
  v_mov_b32 v1, 0x80808080
  v_lshlrev_b32 v19, 9, v2
  v_lshl_add_u32 v19, v3, 4, v19
  s_waitcnt vmcnt(0)
  v_readfirstlane_b32 s20, v7
  s_nop 3
  s_add_u32 s20, s20, 0x9e3779b9
  s_bfe_u32 s84, s20, 0x80000
  s_bfe_u32 s85, s20, 0x80008
  s_bfe_u32 s86, s20, 0x80010
  s_bfe_u32 s87, s20, 0x80018
  v_mov_b32 v16, s20
  s_barrier
  s_mov_b32 s12, s60
  s_and_b32 s13, s61, 0xffff
  s_mov_b32 s14, 4194304
  s_mov_b32 s15, 0x20000
  s_lshr_b32 s6, s2, 5
  v_and_b32 v6, 3, v3
  v_lshlrev_b32 v6, 10, v6
  v_lshl_add_u32 v6, v2, 4, v6
  v_lshlrev_b32 v5, 16, v2
  v_lshl_add_u32 v5, v3, 4, v5
  s_lshl_b32 s7, s6, 7
  s_lshl_b32 s31, s6, 19
  s_lshl_b32 s4, s34, 8
  s_add_u32 s31, s31, s4
  buffer_load_dwordx4 v[8:11], v6, s[16:19], s7 offen nt
  buffer_load_dwordx4 v[12:15], v6, s[16:19], s7 offen offset:64 nt
  buffer_load_dwordx4 v[24:27], v5, s[12:15], s31 offen nt
  s_add_u32 s31, s31, 8192
  buffer_load_dwordx4 v[28:31], v5, s[12:15], s31 offen nt
  s_add_u32 s31, s31, 8192
  buffer_load_dwordx4 v[32:35], v5, s[12:15], s31 offen nt
  s_add_u32 s31, s31, 8192
  buffer_load_dwordx4 v[36:39], v5, s[12:15], s31 offen nt
  s_add_u32 s31, s31, 8192
  buffer_load_dwordx4 v[40:43], v5, s[12:15], s31 offen nt
  s_add_u32 s31, s31, 8192
  buffer_load_dwordx4 v[44:47], v5, s[12:15], s31 offen nt
  s_add_u32 s31, s31, 8192
  buffer_load_dwordx4 v[48:51], v5, s[12:15], s31 offen nt
  s_add_u32 s31, s31, 8192
  buffer_load_dwordx4 v[52:55], v5, s[12:15], s31 offen nt
  s_add_u32 s31, s31, 204800
  buffer_load_dwordx4 v[56:59], v5, s[12:15], s31 offen nt
  s_add_u32 s31, s31, 8192
  buffer_load_dwordx4 v[60:63], v5, s[12:15], s31 offen nt
  s_add_u32 s31, s31, 8192
  buffer_load_dwordx4 v[64:67], v5, s[12:15], s31 offen nt
  s_add_u32 s31, s31, 8192
  buffer_load_dwordx4 v[68:71], v5, s[12:15], s31 offen nt
  s_add_u32 s31, s31, 8192
  buffer_load_dwordx4 v[72:75], v5, s[12:15], s31 offen nt
  s_add_u32 s31, s31, 8192
  buffer_load_dwordx4 v[76:79], v5, s[12:15], s31 offen nt
  s_add_u32 s31, s31, 8192
  buffer_load_dwordx4 v[80:83], v5, s[12:15], s31 offen nt
  s_add_u32 s31, s31, 8192
  buffer_load_dwordx4 v[84:87], v5, s[12:15], s31 offen nt
  s_mov_b32 s12, s62
  s_and_b32 s13, s63, 0xffff
  s_mov_b32 s14, 4194304
  s_mov_b32 s15, 0x20000
  v_lshlrev_b32 v5, 10, v2
  v_lshl_add_u32 v5, v3, 4, v5
  s_lshl_b32 s92, s34, 17
  s_lshl_b32 s93, s36, 16
  s_add_u32 s92, s92, s93
  s_lshl_b32 s93, s37, 8
  s_add_u32 s92, s92, s93
  s_add_u32 s31, s92, 0
  buffer_load_dwordx4 v[88:91], v5, s[12:15], s31 offen nt
  s_add_u32 s31, s92, 8192
  buffer_load_dwordx4 v[92:95], v5, s[12:15], s31 offen nt
  s_add_u32 s31, s92, 16384
  buffer_load_dwordx4 v[96:99], v5, s[12:15], s31 offen nt
  s_add_u32 s31, s92, 24576
  buffer_load_dwordx4 v[100:103], v5, s[12:15], s31 offen nt
  s_add_u32 s31, s92, 32768
  buffer_load_dwordx4 v[104:107], v5, s[12:15], s31 offen nt
  s_add_u32 s31, s92, 40960
  buffer_load_dwordx4 v[108:111], v5, s[12:15], s31 offen nt
  s_add_u32 s31, s92, 49152
  buffer_load_dwordx4 v[112:115], v5, s[12:15], s31 offen nt
  s_add_u32 s31, s92, 57344
  buffer_load_dwordx4 v[116:119], v5, s[12:15], s31 offen nt
  s_add_u32 s31, s92, 4096
  buffer_load_dwordx4 v[120:123], v5, s[12:15], s31 offen nt
  s_add_u32 s31, s92, 12288
  buffer_load_dwordx4 v[124:127], v5, s[12:15], s31 offen nt
  s_add_u32 s31, s92, 20480
  buffer_load_dwordx4 v[128:131], v5, s[12:15], s31 offen nt
  s_add_u32 s31, s92, 28672
  buffer_load_dwordx4 v[132:135], v5, s[12:15], s31 offen nt
  s_add_u32 s31, s92, 36864
  buffer_load_dwordx4 v[136:139], v5, s[12:15], s31 offen nt
  s_add_u32 s31, s92, 45056
  buffer_load_dwordx4 v[140:143], v5, s[12:15], s31 offen nt
  s_add_u32 s31, s92, 53248
  buffer_load_dwordx4 v[144:147], v5, s[12:15], s31 offen nt
  s_add_u32 s31, s92, 61440
  buffer_load_dwordx4 v[148:151], v5, s[12:15], s31 offen nt
  s_barrier
  s_barrier
  s_lshl_b32 s7, s34, 3
  s_add_u32 s7, s7, s6
  s_lshl_b32 s7, s7, 11
  s_add_u32 s7, s7, 593920
  s_waitcnt vmcnt(24)
  v_perm_b32 v152, v28, v24, s28
  v_perm_b32 v153, v36, v32, s28
  v_perm_b32 v154, v44, v40, s28
  v_perm_b32 v155, v52, v48, s28
  v_perm_b32 v156, v28, v24, s29
  v_perm_b32 v157, v36, v32, s29
  v_perm_b32 v158, v44, v40, s29
  v_perm_b32 v159, v52, v48, s29
  v_mfma_f32_16x16x32_bf16 v[160:163], v[8:11], v[152:155], 0
  v_perm_b32 v152, v29, v25, s28
  v_perm_b32 v153, v37, v33, s28
  v_perm_b32 v154, v45, v41, s28
  v_perm_b32 v155, v53, v49, s28
  v_mfma_f32_16x16x32_bf16 v[164:167], v[8:11], v[156:159], 0
  v_perm_b32 v156, v29, v25, s29
  v_perm_b32 v157, v37, v33, s29
  v_perm_b32 v158, v45, v41, s29
  v_perm_b32 v159, v53, v49, s29
  v_mfma_f32_16x16x32_bf16 v[168:171], v[8:11], v[152:155], 0
  v_perm_b32 v152, v30, v26, s28
  v_perm_b32 v153, v38, v34, s28
  v_perm_b32 v154, v46, v42, s28
  v_perm_b32 v155, v54, v50, s28
  v_mfma_f32_16x16x32_bf16 v[172:175], v[8:11], v[156:159], 0
  v_perm_b32 v156, v30, v26, s29
  v_perm_b32 v157, v38, v34, s29
  v_perm_b32 v158, v46, v42, s29
  v_perm_b32 v159, v54, v50, s29
  v_mfma_f32_16x16x32_bf16 v[176:179], v[8:11], v[152:155], 0
  v_perm_b32 v152, v31, v27, s28
  v_perm_b32 v153, v39, v35, s28
  v_perm_b32 v154, v47, v43, s28
  v_perm_b32 v155, v55, v51, s28
  v_mfma_f32_16x16x32_bf16 v[180:183], v[8:11], v[156:159], 0
  v_perm_b32 v156, v31, v27, s29
  v_perm_b32 v157, v39, v35, s29
  v_perm_b32 v158, v47, v43, s29
  v_perm_b32 v159, v55, v51, s29
  v_mfma_f32_16x16x32_bf16 v[184:187], v[8:11], v[152:155], 0
  s_nop 0
  v_mfma_f32_16x16x32_bf16 v[188:191], v[8:11], v[156:159], 0
  s_waitcnt vmcnt(16)
  v_perm_b32 v152, v60, v56, s28
  v_perm_b32 v153, v68, v64, s28
  v_perm_b32 v154, v76, v72, s28
  v_perm_b32 v155, v84, v80, s28
  v_perm_b32 v156, v60, v56, s29
  v_perm_b32 v157, v68, v64, s29
  v_perm_b32 v158, v76, v72, s29
  v_perm_b32 v159, v84, v80, s29
  v_mfma_f32_16x16x32_bf16 v[160:163], v[12:15], v[152:155], v[160:163]
  v_perm_b32 v152, v61, v57, s28
  v_perm_b32 v153, v69, v65, s28
  v_perm_b32 v154, v77, v73, s28
  v_perm_b32 v155, v85, v81, s28
  v_mfma_f32_16x16x32_bf16 v[164:167], v[12:15], v[156:159], v[164:167]
  v_perm_b32 v156, v61, v57, s29
  v_perm_b32 v157, v69, v65, s29
  v_perm_b32 v158, v77, v73, s29
  v_perm_b32 v159, v85, v81, s29
  v_mfma_f32_16x16x32_bf16 v[168:171], v[12:15], v[152:155], v[168:171]
  v_perm_b32 v152, v62, v58, s28
  v_perm_b32 v153, v70, v66, s28
  v_perm_b32 v154, v78, v74, s28
  v_perm_b32 v155, v86, v82, s28
  v_mfma_f32_16x16x32_bf16 v[172:175], v[12:15], v[156:159], v[172:175]
  v_perm_b32 v156, v62, v58, s29
  v_perm_b32 v157, v70, v66, s29
  v_perm_b32 v158, v78, v74, s29
  v_perm_b32 v159, v86, v82, s29
  v_mfma_f32_16x16x32_bf16 v[176:179], v[12:15], v[152:155], v[176:179]
  v_perm_b32 v152, v63, v59, s28
  v_perm_b32 v153, v71, v67, s28
  v_perm_b32 v154, v79, v75, s28
  v_perm_b32 v155, v87, v83, s28
  v_mfma_f32_16x16x32_bf16 v[180:183], v[12:15], v[156:159], v[180:183]
  v_perm_b32 v156, v63, v59, s29
  v_perm_b32 v157, v71, v67, s29
  v_perm_b32 v158, v79, v75, s29
  v_perm_b32 v159, v87, v83, s29
  v_mfma_f32_16x16x32_bf16 v[184:187], v[12:15], v[152:155], v[184:187]
  s_nop 0
  v_mfma_f32_16x16x32_bf16 v[188:191], v[12:15], v[156:159], v[188:191]
  s_nop 7
  v_cndmask_b32 v24, v160, v161, s[22:23]
  v_cndmask_b32 v25, v164, v165, s[22:23]
  v_cndmask_b32 v26, v168, v169, s[22:23]
  v_cndmask_b32 v27, v172, v173, s[22:23]
  v_cndmask_b32 v28, v176, v177, s[22:23]
  v_cndmask_b32 v29, v180, v181, s[22:23]
  v_cndmask_b32 v30, v184, v185, s[22:23]
  v_cndmask_b32 v31, v188, v189, s[22:23]
  v_cndmask_b32 v24, v24, v162, s[24:25]
  v_cndmask_b32 v25, v25, v166, s[24:25]
  v_cndmask_b32 v26, v26, v170, s[24:25]
  v_cndmask_b32 v27, v27, v174, s[24:25]
  v_cndmask_b32 v28, v28, v178, s[24:25]
  v_cndmask_b32 v29, v29, v182, s[24:25]
  v_cndmask_b32 v30, v30, v186, s[24:25]
  v_cndmask_b32 v31, v31, v190, s[24:25]
  v_cndmask_b32 v24, v24, v163, s[26:27]
  v_cndmask_b32 v25, v25, v167, s[26:27]
  v_cndmask_b32 v26, v26, v171, s[26:27]
  v_cndmask_b32 v27, v27, v175, s[26:27]
  v_cndmask_b32 v28, v28, v179, s[26:27]
  v_cndmask_b32 v29, v29, v183, s[26:27]
  v_cndmask_b32 v30, v30, v187, s[26:27]
  v_cndmask_b32 v31, v31, v191, s[26:27]
  v_perm_b32 v24, v24, v16, s88
  v_perm_b32 v25, v25, v16, s89
  v_perm_b32 v26, v26, v16, s90
  v_perm_b32 v27, v27, v16, s91
  v_perm_b32 v28, v28, v16, s88
  v_perm_b32 v29, v29, v16, s89
  v_perm_b32 v30, v30, v16, s90
  v_perm_b32 v31, v31, v16, s91
  buffer_store_dwordx4 v[24:27], v19, s[8:11], s7 offen offset:0 sc1 nt
  buffer_store_dwordx4 v[28:31], v19, s[8:11], s7 offen offset:256 sc1 nt
  s_waitcnt vmcnt(0)
  v_perm_b32 v192, v92, v88, s28
  v_perm_b32 v193, v100, v96, s28
  v_perm_b32 v194, v108, v104, s28
  v_perm_b32 v195, v116, v112, s28
  v_perm_b32 v196, v92, v88, s29
  v_perm_b32 v197, v100, v96, s29
  v_perm_b32 v198, v108, v104, s29
  v_perm_b32 v199, v116, v112, s29
  v_perm_b32 v200, v93, v89, s28
  v_perm_b32 v201, v101, v97, s28
  v_perm_b32 v202, v109, v105, s28
  v_perm_b32 v203, v117, v113, s28
  v_perm_b32 v204, v93, v89, s29
  v_perm_b32 v205, v101, v97, s29
  v_perm_b32 v206, v109, v105, s29
  v_perm_b32 v207, v117, v113, s29
  v_perm_b32 v208, v94, v90, s28
  v_perm_b32 v209, v102, v98, s28
  v_perm_b32 v210, v110, v106, s28
  v_perm_b32 v211, v118, v114, s28
  v_perm_b32 v212, v94, v90, s29
  v_perm_b32 v213, v102, v98, s29
  v_perm_b32 v214, v110, v106, s29
  v_perm_b32 v215, v118, v114, s29
  v_perm_b32 v216, v95, v91, s28
  v_perm_b32 v217, v103, v99, s28
  v_perm_b32 v218, v111, v107, s28
  v_perm_b32 v219, v119, v115, s28
  v_perm_b32 v220, v95, v91, s29
  v_perm_b32 v221, v103, v99, s29
  v_perm_b32 v222, v111, v107, s29
  v_perm_b32 v223, v119, v115, s29
  v_perm_b32 v224, v124, v120, s28
  v_perm_b32 v225, v132, v128, s28
  v_perm_b32 v226, v140, v136, s28
  v_perm_b32 v227, v148, v144, s28
  v_perm_b32 v228, v124, v120, s29
  v_perm_b32 v229, v132, v128, s29
  v_perm_b32 v230, v140, v136, s29
  v_perm_b32 v231, v148, v144, s29
  v_perm_b32 v232, v125, v121, s28
  v_perm_b32 v233, v133, v129, s28
  v_perm_b32 v234, v141, v137, s28
  v_perm_b32 v235, v149, v145, s28
  v_perm_b32 v236, v125, v121, s29
  v_perm_b32 v237, v133, v129, s29
  v_perm_b32 v238, v141, v137, s29
  v_perm_b32 v239, v149, v145, s29
  v_perm_b32 v240, v126, v122, s28
  v_perm_b32 v241, v134, v130, s28
  v_perm_b32 v242, v142, v138, s28
  v_perm_b32 v243, v150, v146, s28
  v_perm_b32 v244, v126, v122, s29
  v_perm_b32 v245, v134, v130, s29
  v_perm_b32 v246, v142, v138, s29
  v_perm_b32 v247, v150, v146, s29
  v_perm_b32 v248, v127, v123, s28
  v_perm_b32 v249, v135, v131, s28
  v_perm_b32 v250, v143, v139, s28
  v_perm_b32 v251, v151, v147, s28
  v_perm_b32 v252, v127, v123, s29
  v_perm_b32 v253, v135, v131, s29
  v_perm_b32 v254, v143, v139, s29
  v_perm_b32 v255, v151, v147, s29
  s_mov_b32 s12, s64
  s_and_b32 s13, s65, 0xffff
  s_mov_b32 s14, 1024
  s_mov_b32 s15, 0x20000
  buffer_load_dwordx4 v[24:27], v4, s[16:19], 0 offen offset:0 nt
  buffer_load_dwordx4 v[28:31], v4, s[16:19], 0 offen offset:1024 nt
  buffer_load_dwordx4 v[32:35], v4, s[16:19], 0 offen offset:2048 nt
  buffer_load_dwordx4 v[36:39], v4, s[16:19], 0 offen offset:3072 nt
  buffer_load_dwordx4 v[40:43], v4, s[12:15], 0 offen nt
  s_waitcnt vmcnt(0)
  v_lshlrev_b32 v44, 16, v40
  v_and_b32 v45, s39, v40
  v_lshlrev_b32 v46, 16, v41
  v_and_b32 v47, s39, v41
  v_lshlrev_b32 v48, 16, v42
  v_and_b32 v49, s39, v42
  v_lshlrev_b32 v50, 16, v43
  v_and_b32 v51, s39, v43
  v_lshlrev_b32 v52, 16, v24
  v_and_b32 v53, s39, v24
  v_lshlrev_b32 v54, 16, v25
  v_and_b32 v55, s39, v25
  v_lshlrev_b32 v56, 16, v26
  v_and_b32 v57, s39, v26
  v_lshlrev_b32 v58, 16, v27
  v_and_b32 v59, s39, v27
  v_mul_f32 v52, v52, v44
  v_mul_f32 v53, v53, v45
  v_mul_f32 v54, v54, v46
  v_mul_f32 v55, v55, v47
  v_mul_f32 v56, v56, v48
  v_mul_f32 v57, v57, v49
  v_mul_f32 v58, v58, v50
  v_mul_f32 v59, v59, v51
  v_cvt_pk_bf16_f32 v24, v52, v53
  v_cvt_pk_bf16_f32 v25, v54, v55
  v_cvt_pk_bf16_f32 v26, v56, v57
  v_cvt_pk_bf16_f32 v27, v58, v59
  v_lshlrev_b32 v52, 16, v24
  v_and_b32 v53, s39, v24
  v_lshlrev_b32 v54, 16, v25
  v_and_b32 v55, s39, v25
  v_lshlrev_b32 v56, 16, v26
  v_and_b32 v57, s39, v26
  v_lshlrev_b32 v58, 16, v27
  v_and_b32 v59, s39, v27
  v_add_f32 v52, v52, v56
  v_add_f32 v53, v53, v57
  v_add_f32 v54, v54, v58
  v_add_f32 v55, v55, v59
  v_add_f32 v52, v52, v54
  v_add_f32 v53, v53, v55
  v_add_f32 v60, v52, v53
  v_lshlrev_b32 v52, 16, v28
  v_and_b32 v53, s39, v28
  v_lshlrev_b32 v54, 16, v29
  v_and_b32 v55, s39, v29
  v_lshlrev_b32 v56, 16, v30
  v_and_b32 v57, s39, v30
  v_lshlrev_b32 v58, 16, v31
  v_and_b32 v59, s39, v31
  v_mul_f32 v52, v52, v44
  v_mul_f32 v53, v53, v45
  v_mul_f32 v54, v54, v46
  v_mul_f32 v55, v55, v47
  v_mul_f32 v56, v56, v48
  v_mul_f32 v57, v57, v49
  v_mul_f32 v58, v58, v50
  v_mul_f32 v59, v59, v51
  v_cvt_pk_bf16_f32 v28, v52, v53
  v_cvt_pk_bf16_f32 v29, v54, v55
  v_cvt_pk_bf16_f32 v30, v56, v57
  v_cvt_pk_bf16_f32 v31, v58, v59
  v_lshlrev_b32 v52, 16, v28
  v_and_b32 v53, s39, v28
  v_lshlrev_b32 v54, 16, v29
  v_and_b32 v55, s39, v29
  v_lshlrev_b32 v56, 16, v30
  v_and_b32 v57, s39, v30
  v_lshlrev_b32 v58, 16, v31
  v_and_b32 v59, s39, v31
  v_add_f32 v52, v52, v56
  v_add_f32 v53, v53, v57
  v_add_f32 v54, v54, v58
  v_add_f32 v55, v55, v59
  v_add_f32 v52, v52, v54
  v_add_f32 v53, v53, v55
  v_add_f32 v61, v52, v53
  v_lshlrev_b32 v52, 16, v32
  v_and_b32 v53, s39, v32
  v_lshlrev_b32 v54, 16, v33
  v_and_b32 v55, s39, v33
  v_lshlrev_b32 v56, 16, v34
  v_and_b32 v57, s39, v34
  v_lshlrev_b32 v58, 16, v35
  v_and_b32 v59, s39, v35
  v_mul_f32 v52, v52, v44
  v_mul_f32 v53, v53, v45
  v_mul_f32 v54, v54, v46
  v_mul_f32 v55, v55, v47
  v_mul_f32 v56, v56, v48
  v_mul_f32 v57, v57, v49
  v_mul_f32 v58, v58, v50
  v_mul_f32 v59, v59, v51
  v_cvt_pk_bf16_f32 v32, v52, v53
  v_cvt_pk_bf16_f32 v33, v54, v55
  v_cvt_pk_bf16_f32 v34, v56, v57
  v_cvt_pk_bf16_f32 v35, v58, v59
  v_lshlrev_b32 v52, 16, v32
  v_and_b32 v53, s39, v32
  v_lshlrev_b32 v54, 16, v33
  v_and_b32 v55, s39, v33
  v_lshlrev_b32 v56, 16, v34
  v_and_b32 v57, s39, v34
  v_lshlrev_b32 v58, 16, v35
  v_and_b32 v59, s39, v35
  v_add_f32 v52, v52, v56
  v_add_f32 v53, v53, v57
  v_add_f32 v54, v54, v58
  v_add_f32 v55, v55, v59
  v_add_f32 v52, v52, v54
  v_add_f32 v53, v53, v55
  v_add_f32 v62, v52, v53
  v_lshlrev_b32 v52, 16, v36
  v_and_b32 v53, s39, v36
  v_lshlrev_b32 v54, 16, v37
  v_and_b32 v55, s39, v37
  v_lshlrev_b32 v56, 16, v38
  v_and_b32 v57, s39, v38
  v_lshlrev_b32 v58, 16, v39
  v_and_b32 v59, s39, v39
  v_mul_f32 v52, v52, v44
  v_mul_f32 v53, v53, v45
  v_mul_f32 v54, v54, v46
  v_mul_f32 v55, v55, v47
  v_mul_f32 v56, v56, v48
  v_mul_f32 v57, v57, v49
  v_mul_f32 v58, v58, v50
  v_mul_f32 v59, v59, v51
  v_cvt_pk_bf16_f32 v36, v52, v53
  v_cvt_pk_bf16_f32 v37, v54, v55
  v_cvt_pk_bf16_f32 v38, v56, v57
  v_cvt_pk_bf16_f32 v39, v58, v59
  v_lshlrev_b32 v52, 16, v36
  v_and_b32 v53, s39, v36
  v_lshlrev_b32 v54, 16, v37
  v_and_b32 v55, s39, v37
  v_lshlrev_b32 v56, 16, v38
  v_and_b32 v57, s39, v38
  v_lshlrev_b32 v58, 16, v39
  v_and_b32 v59, s39, v39
  v_add_f32 v52, v52, v56
  v_add_f32 v53, v53, v57
  v_add_f32 v54, v54, v58
  v_add_f32 v55, v55, v59
  v_add_f32 v52, v52, v54
  v_add_f32 v53, v53, v55
  v_add_f32 v63, v52, v53
  s_nop 0
  v_add_f32_dpp v60, v60, v60 row_ror:8 row_mask:0xf bank_mask:0xf
  v_add_f32_dpp v61, v61, v61 row_ror:8 row_mask:0xf bank_mask:0xf
  v_add_f32_dpp v62, v62, v62 row_ror:8 row_mask:0xf bank_mask:0xf
  v_add_f32_dpp v63, v63, v63 row_ror:8 row_mask:0xf bank_mask:0xf
  s_nop 0
  v_add_f32_dpp v60, v60, v60 row_ror:4 row_mask:0xf bank_mask:0xf
  v_add_f32_dpp v61, v61, v61 row_ror:4 row_mask:0xf bank_mask:0xf
  v_add_f32_dpp v62, v62, v62 row_ror:4 row_mask:0xf bank_mask:0xf
  v_add_f32_dpp v63, v63, v63 row_ror:4 row_mask:0xf bank_mask:0xf
  s_nop 0
  v_add_f32_dpp v60, v60, v60 row_ror:2 row_mask:0xf bank_mask:0xf
  v_add_f32_dpp v61, v61, v61 row_ror:2 row_mask:0xf bank_mask:0xf
  v_add_f32_dpp v62, v62, v62 row_ror:2 row_mask:0xf bank_mask:0xf
  v_add_f32_dpp v63, v63, v63 row_ror:2 row_mask:0xf bank_mask:0xf
  s_nop 0
  v_add_f32_dpp v60, v60, v60 row_ror:1 row_mask:0xf bank_mask:0xf
  v_add_f32_dpp v61, v61, v61 row_ror:1 row_mask:0xf bank_mask:0xf
  v_add_f32_dpp v62, v62, v62 row_ror:1 row_mask:0xf bank_mask:0xf
  v_add_f32_dpp v63, v63, v63 row_ror:1 row_mask:0xf bank_mask:0xf
  v_mov_b32 v64, v60
  v_mov_b32 v65, v61
  v_mov_b32 v66, v62
  v_mov_b32 v67, v63
  v_permlane32_swap_b32 v60, v64
  v_permlane32_swap_b32 v61, v65
  v_permlane32_swap_b32 v62, v66
  v_permlane32_swap_b32 v63, v67
  v_add_f32 v60, v60, v64
  v_add_f32 v61, v61, v65
  v_add_f32 v62, v62, v66
  v_add_f32 v63, v63, v67
  v_mov_b32 v64, v60
  v_mov_b32 v65, v61
  v_mov_b32 v66, v62
  v_mov_b32 v67, v63
  v_permlane16_swap_b32 v60, v64
  v_permlane16_swap_b32 v61, v65
  v_permlane16_swap_b32 v62, v66
  v_permlane16_swap_b32 v63, v67
  v_add_f32 v60, v60, v64
  v_add_f32 v61, v61, v65
  v_add_f32 v62, v62, v66
  v_add_f32 v63, v63, v67
  v_cvt_pk_bf16_f32 v60, v60, v60
  v_cvt_pk_bf16_f32 v61, v61, v61
  v_cvt_pk_bf16_f32 v62, v62, v62
  v_cvt_pk_bf16_f32 v63, v63, v63
  v_lshlrev_b32 v60, 16, v60
  v_lshlrev_b32 v61, 16, v61
  v_lshlrev_b32 v62, 16, v62
  v_lshlrev_b32 v63, 16, v63
  v_mul_f32 v60, s30, v60
  v_mul_f32 v61, s30, v61
  v_mul_f32 v62, s30, v62
  v_mul_f32 v63, s30, v63
  v_sub_f32 v60, 0, v60
  v_sub_f32 v61, 0, v61
  v_sub_f32 v62, 0, v62
  v_sub_f32 v63, 0, v63
  v_exp_f32 v60, v60
  v_exp_f32 v61, v61
  v_exp_f32 v62, v62
  v_exp_f32 v63, v63
  s_nop 0
  v_add_f32 v60, 1.0, v60
  v_add_f32 v61, 1.0, v61
  v_add_f32 v62, 1.0, v62
  v_add_f32 v63, 1.0, v63
  v_rcp_f32 v60, v60
  v_rcp_f32 v61, v61
  v_rcp_f32 v62, v62
  v_rcp_f32 v63, v63
  s_nop 0
  v_cvt_pk_bf16_f32 v60, v60, v60
  v_cvt_pk_bf16_f32 v61, v61, v61
  v_cvt_pk_bf16_f32 v62, v62, v62
  v_cvt_pk_bf16_f32 v63, v63, v63
  v_lshlrev_b32 v68, 16, v60
  v_lshlrev_b32 v70, 16, v61
  v_lshlrev_b32 v72, 16, v62
  v_lshlrev_b32 v74, 16, v63
  v_sub_f32 v69, 1.0, v68
  v_sub_f32 v71, 1.0, v70
  v_sub_f32 v73, 1.0, v72
  v_sub_f32 v75, 1.0, v74
  v_cvt_pk_bf16_f32 v69, v69, v69
  v_cvt_pk_bf16_f32 v71, v71, v71
  v_cvt_pk_bf16_f32 v73, v73, v73
  v_cvt_pk_bf16_f32 v75, v75, v75
  v_lshlrev_b32 v69, 16, v69
  v_lshlrev_b32 v71, 16, v71
  v_lshlrev_b32 v73, 16, v73
  v_lshlrev_b32 v75, 16, v75
  v_mov_b32 v6, 0
  s_mov_b64 exec, 1
  ds_write_b128 v6, v[68:71] offset:11776
  ds_write_b128 v6, v[72:75] offset:11792
  s_mov_b64 exec, -1
  s_waitcnt lgkmcnt(0)
  v_lshlrev_b32 v6, 3, v2
  ds_read_b32 v18, v6 offset:11780
  v_lshlrev_b32 v6, 11, v2
  v_lshl_add_u32 v6, v3, 4, v6
  s_lshl_b32 s4, s34, 14
  s_lshl_b32 s5, s35, 9
  s_add_u32 s4, s4, s5
  s_lshr_b32 s6, s2, 7
  s_lshl_b32 s5, s6, 8
  s_add_u32 s4, s4, s5
  s_add_u32 s4, s4, 593920
  s_add_u32 s5, s4, 8192
L_qbc:
  buffer_load_dwordx4 v[24:27], v6, s[8:11], s4 offen sc1 nt
  buffer_load_dwordx4 v[28:31], v6, s[8:11], s5 offen sc1 nt
  s_waitcnt vmcnt(0)
  v_xor_b32 v152, s84, v24
  v_bitop3_b32 v152, v152, v25, s85 bitop3:0xf6
  v_bitop3_b32 v152, v152, v26, s86 bitop3:0xf6
  v_bitop3_b32 v152, v152, v27, s87 bitop3:0xf6
  v_bitop3_b32 v152, v152, v28, s84 bitop3:0xf6
  v_bitop3_b32 v152, v152, v29, s85 bitop3:0xf6
  v_bitop3_b32 v152, v152, v30, s86 bitop3:0xf6
  v_bitop3_b32 v152, v152, v31, s87 bitop3:0xf6
  v_and_b32 v152, 0xff, v152
  v_cmp_ne_u32 vcc, 0, v152
  s_cbranch_vccz L_ok_6
  s_sub_u32 s32, s32, 1
  s_cmp_eq_u32 s32, 0
  s_cbranch_scc1 L_ok_6
  s_sleep 8
  s_branch L_qbc
L_ok_6:
  v_perm_b32 v24, v24, v1, s88
  v_perm_b32 v25, v25, v1, s88
  v_perm_b32 v26, v26, v1, s88
  v_perm_b32 v27, v27, v1, s88
  v_perm_b32 v28, v28, v1, s88
  v_perm_b32 v29, v29, v1, s88
  v_perm_b32 v30, v30, v1, s88
  v_perm_b32 v31, v31, v1, s88
  v_add_f32 v24, v24, v28
  v_add_f32 v25, v25, v29
  v_add_f32 v26, v26, v30
  v_add_f32 v27, v27, v31
  v_mov_b32 v28, v24
  v_mov_b32 v29, v25
  v_mov_b32 v30, v26
  v_mov_b32 v31, v27
  v_permlane32_swap_b32 v24, v28
  v_permlane32_swap_b32 v25, v29
  v_permlane32_swap_b32 v26, v30
  v_permlane32_swap_b32 v27, v31
  v_add_f32 v24, v24, v28
  v_add_f32 v25, v25, v29
  v_add_f32 v26, v26, v30
  v_add_f32 v27, v27, v31
  v_mov_b32 v28, v24
  v_mov_b32 v29, v25
  v_mov_b32 v30, v26
  v_mov_b32 v31, v27
  v_permlane16_swap_b32 v24, v28
  v_permlane16_swap_b32 v25, v29
  v_permlane16_swap_b32 v26, v30
  v_permlane16_swap_b32 v27, v31
  v_add_f32 v24, v24, v28
  v_add_f32 v25, v25, v29
  v_add_f32 v26, v26, v30
  v_add_f32 v27, v27, v31
  v_cvt_pk_bf16_f32 v24, v24, v25
  v_cvt_pk_bf16_f32 v26, v26, v27
  v_mov_b32 v25, s20
  v_mov_b32 v27, s20
  s_lshl_b32 s4, s34, 11
  s_lshl_b32 s5, s35, 9
  s_add_u32 s4, s4, s5
  s_lshl_b32 s5, s6, 8
  s_add_u32 s4, s4, s5
  s_add_u32 s4, s4, 1118208
  s_mov_b64 exec, 0xffff
  buffer_store_dwordx4 v[24:27], v4, s[8:11], s4 offen sc1
  s_mov_b64 exec, -1
  s_barrier
  v_lshlrev_b32 v6, 11, v2
  v_lshl_add_u32 v6, v3, 4, v6
  s_bfe_u32 s4, s2, 0x30003
  s_lshl_b32 s4, s4, 13
  s_lshr_b32 s5, s2, 6
  s_lshl_b32 s5, s5, 9
  s_add_u32 s4, s4, s5
  s_add_u32 s4, s4, 1118208
L_qbg:
  buffer_load_dwordx4 v[32:35], v6, s[8:11], s4 offen offset:0 sc1
  buffer_load_dwordx4 v[36:39], v6, s[8:11], s4 offen offset:256 sc1
  s_waitcnt vmcnt(0)
  v_xor_b32 v152, s20, v33
  v_bitop3_b32 v152, v152, v35, s20 bitop3:0xf6
  v_bitop3_b32 v152, v152, v37, s20 bitop3:0xf6
  v_bitop3_b32 v152, v152, v39, s20 bitop3:0xf6
  v_cmp_ne_u32 vcc, 0, v152
  s_cbranch_vccz L_ok_7
  s_sub_u32 s32, s32, 1
  s_cmp_eq_u32 s32, 0
  s_cbranch_scc1 L_ok_7
  s_sleep 8
  s_branch L_qbg
L_ok_7:
  v_lshlrev_b32 v6, 8, v2
  v_lshl_add_u32 v6, v3, 4, v6
  v_mov_b32 v33, v34
  ds_write_b64 v6, v[32:33] offset:256
  v_mov_b32 v37, v38
  ds_write_b64 v6, v[36:37] offset:264
  s_waitcnt lgkmcnt(0)
  v_bfe_u32 v152, v0, 1, 1
  v_lshlrev_b32 v17, 8, v152
  v_bfe_u32 v152, v0, 2, 3
  v_lshl_add_u32 v17, v152, 5, v17
  v_and_b32 v152, 1, v0
  v_lshl_add_u32 v17, v152, 4, v17
  v_lshrrev_b32 v152, 5, v0
  v_and_b32 v153, 31, v0
  v_lshlrev_b32 v20, 4, v153
  v_mul_u32_u24 v153, 4096, v152
  v_add_u32 v17, v17, v153
  v_lshl_add_u32 v20, v152, 9, v20
  v_lshlrev_b32 v21, 5, v152
  v_mul_u32_u24 v8, 131072, v2
  v_lshl_add_u32 v8, v3, 4, v8
  v_lshlrev_b32 v9, 13, v2
  v_and_b32 v152, 7, v3
  v_lshl_add_u32 v9, v152, 7, v9
  s_mul_i32 s42, s34, 4096
  s_lshl_b32 s5, s36, 8
  s_add_u32 s42, s42, s5
  s_add_u32 s42, s42, 1314816
  s_lshr_b32 s43, s34, 2
  s_lshl_b32 s43, s43, 10
  s_and_b32 s5, s34, 3
  s_lshl_b32 s5, s5, 4
  s_add_u32 s43, s43, s5
  s_add_u32 s43, s43, 4096
  s_lshr_b32 s4, s2, 6
  s_lshl_b32 s4, s4, 8
  s_bfe_u32 s5, s2, 0x30003
  s_lshl_b32 s5, s5, 5
  s_add_u32 s4, s4, s5
  s_and_b32 s5, s2, 7
  s_add_u32 s4, s4, s5
  s_lshl_b32 s40, s4, 9
  s_add_u32 s40, s40, 1314816
  s_lshl_b32 s41, s2, 7
  s_add_u32 s41, s41, 4096
  s_barrier
  s_barrier
  ds_read_b128 v[32:35], v20 offset:6144
  ds_read_b128 v[40:43], v21 offset:10496
  ds_read_b32 v48, v21 offset:10512
  ds_read_b128 v[36:39], v20 offset:8192
  ds_read_b128 v[44:47], v21 offset:10624
  ds_read_b32 v49, v21 offset:10640
  s_waitcnt lgkmcnt(0)
  v_max_f32 v28, v48, v49
  v_sub_f32 v50, v48, v28
  v_sub_f32 v51, v49, v28
  v_mul_f32 v50, s30, v50
  v_mul_f32 v51, s30, v51
  v_exp_f32 v50, v50
  v_exp_f32 v51, v51
  v_add_f32 v40, v40, v41
  v_add_f32 v42, v42, v43
  v_add_f32 v44, v44, v45
  v_add_f32 v46, v46, v47
  v_mul_f32 v24, v50, v32
  v_mul_f32 v25, v50, v33
  v_mul_f32 v26, v50, v34
  v_mul_f32 v27, v50, v35
  v_fmac_f32 v24, v51, v36
  v_fmac_f32 v25, v51, v37
  v_fmac_f32 v26, v51, v38
  v_fmac_f32 v27, v51, v39
  v_perm_b32 v24, v24, v16, s88
  v_perm_b32 v25, v25, v16, s89
  v_perm_b32 v26, v26, v16, s90
  v_perm_b32 v27, v27, v16, s91
  v_add_f32 v40, v40, v42
  v_add_f32 v44, v44, v46
  v_mov_b32 v29, s20
  v_mul_f32 v30, v50, v40
  v_mov_b32 v31, s20
  v_fmac_f32 v30, v51, v44
  ds_read_b128 v[64:67], v20 offset:7168
  ds_read_b128 v[72:75], v21 offset:10560
  ds_read_b32 v80, v21 offset:10576
  ds_read_b128 v[68:71], v20 offset:9216
  ds_read_b128 v[76:79], v21 offset:10688
  ds_read_b32 v81, v21 offset:10704
  s_waitcnt lgkmcnt(0)
  v_max_f32 v60, v80, v81
  v_sub_f32 v82, v80, v60
  v_sub_f32 v83, v81, v60
  v_mul_f32 v82, s30, v82
  v_mul_f32 v83, s30, v83
  v_exp_f32 v82, v82
  v_exp_f32 v83, v83
  v_add_f32 v72, v72, v73
  v_add_f32 v74, v74, v75
  v_add_f32 v76, v76, v77
  v_add_f32 v78, v78, v79
  v_mul_f32 v56, v82, v64
  v_mul_f32 v57, v82, v65
  v_mul_f32 v58, v82, v66
  v_mul_f32 v59, v82, v67
  v_fmac_f32 v56, v83, v68
  v_fmac_f32 v57, v83, v69
  v_fmac_f32 v58, v83, v70
  v_fmac_f32 v59, v83, v71
  v_perm_b32 v56, v56, v16, s88
  v_perm_b32 v57, v57, v16, s89
  v_perm_b32 v58, v58, v16, s90
  v_perm_b32 v59, v59, v16, s91
  v_add_f32 v72, v72, v74
  v_add_f32 v76, v76, v78
  v_mov_b32 v61, s20
  v_mul_f32 v62, v82, v72
  v_mov_b32 v63, s20
  v_fmac_f32 v62, v83, v76
  s_mov_b32 s4, 0xaaaaaaaa
  s_mov_b32 s5, 0xaaaaaaaa
  v_cndmask_b32 v28, v28, v60, s[4:5]
  v_cndmask_b32 v29, v29, v61, s[4:5]
  v_cndmask_b32 v30, v30, v62, s[4:5]
  v_cndmask_b32 v31, v31, v63, s[4:5]
  v_lshrrev_b32 v6, 5, v0
  v_and_b32 v7, 1, v0
  v_lshl_add_u32 v6, v7, 1, v6
  v_bfe_u32 v7, v0, 1, 1
  v_lshl_add_u32 v6, v7, 2, v6
  v_lshlrev_b32 v6, 4, v6
  s_barrier
  buffer_store_dwordx4 v[24:27], v17, s[8:11], s40 offen sc1
  s_add_u32 s40, s40, 8192
  buffer_store_dwordx4 v[56:59], v17, s[8:11], s40 offen sc1
  s_mov_b32 exec_lo, 0xf
  s_mov_b32 exec_hi, 0xf
  buffer_store_dwordx4 v[28:31], v6, s[8:11], s41 offen sc1
  s_mov_b64 exec, -1
  buffer_load_dwordx4 v[88:91], v9, s[8:11], s43 offen sc1
  s_waitcnt vmcnt(0)
  v_xor_b32 v152, s20, v89
  v_bitop3_b32 v152, v152, v91, s20 bitop3:0xf6
  v_cmp_ne_u32 vcc, 0, v152
  s_mov_b32 s21, 0
  s_cbranch_vccnz L_pre_done
  s_mov_b32 s21, 1
  v_mov_b32 v56, v88
  v_mov_b32 v57, v89
  v_mov_b32 v58, v90
  v_mov_b32 v59, v91
  buffer_load_dwordx4 v[24:27], v8, s[8:11], s42 offen offset:0 sc1
  buffer_load_dwordx4 v[28:31], v8, s[8:11], s42 offen offset:512 sc1
  buffer_load_dwordx4 v[32:35], v8, s[8:11], s42 offen offset:1024 sc1
  buffer_load_dwordx4 v[36:39], v8, s[8:11], s42 offen offset:1536 sc1
  buffer_load_dwordx4 v[40:43], v8, s[8:11], s42 offen offset:2048 sc1
  buffer_load_dwordx4 v[44:47], v8, s[8:11], s42 offen offset:2560 sc1
  buffer_load_dwordx4 v[48:51], v8, s[8:11], s42 offen offset:3072 sc1
  buffer_load_dwordx4 v[52:55], v8, s[8:11], s42 offen offset:3584 sc1
L_pre_done:
  s_barrier
L_tail_h1:
  s_cmp_eq_u32 s21, 1
  s_cbranch_scc1 L_st2b_have
L_st2b_lp:
  buffer_load_dwordx4 v[56:59], v9, s[8:11], s43 offen sc1
  s_waitcnt vmcnt(0)
  v_xor_b32 v152, s20, v57
  v_bitop3_b32 v152, v152, v59, s20 bitop3:0xf6
  v_cmp_ne_u32 vcc, 0, v152
  s_cbranch_vccz L_ok_8
  s_sub_u32 s32, s32, 1
  s_cmp_eq_u32 s32, 0
  s_cbranch_scc1 L_ok_8
  s_branch L_st2b_lp
L_ok_8:
L_st2b_g:
  buffer_load_dwordx4 v[24:27], v8, s[8:11], s42 offen offset:0 sc1
  buffer_load_dwordx4 v[28:31], v8, s[8:11], s42 offen offset:512 sc1
  buffer_load_dwordx4 v[32:35], v8, s[8:11], s42 offen offset:1024 sc1
  buffer_load_dwordx4 v[36:39], v8, s[8:11], s42 offen offset:1536 sc1
  buffer_load_dwordx4 v[40:43], v8, s[8:11], s42 offen offset:2048 sc1
  buffer_load_dwordx4 v[44:47], v8, s[8:11], s42 offen offset:2560 sc1
  buffer_load_dwordx4 v[48:51], v8, s[8:11], s42 offen offset:3072 sc1
  buffer_load_dwordx4 v[52:55], v8, s[8:11], s42 offen offset:3584 sc1
L_st2b_have:
  s_waitcnt vmcnt(0)
  v_xor_b32 v152, s84, v24
  v_bitop3_b32 v152, v152, v25, s85 bitop3:0xf6
  v_bitop3_b32 v152, v152, v26, s86 bitop3:0xf6
  v_bitop3_b32 v152, v152, v27, s87 bitop3:0xf6
  v_bitop3_b32 v152, v152, v28, s84 bitop3:0xf6
  v_bitop3_b32 v152, v152, v29, s85 bitop3:0xf6
  v_bitop3_b32 v152, v152, v30, s86 bitop3:0xf6
  v_bitop3_b32 v152, v152, v31, s87 bitop3:0xf6
  v_bitop3_b32 v152, v152, v32, s84 bitop3:0xf6
  v_bitop3_b32 v152, v152, v33, s85 bitop3:0xf6
  v_bitop3_b32 v152, v152, v34, s86 bitop3:0xf6
  v_bitop3_b32 v152, v152, v35, s87 bitop3:0xf6
  v_bitop3_b32 v152, v152, v36, s84 bitop3:0xf6
  v_bitop3_b32 v152, v152, v37, s85 bitop3:0xf6
  v_bitop3_b32 v152, v152, v38, s86 bitop3:0xf6
  v_bitop3_b32 v152, v152, v39, s87 bitop3:0xf6
  v_bitop3_b32 v152, v152, v40, s84 bitop3:0xf6
  v_bitop3_b32 v152, v152, v41, s85 bitop3:0xf6
  v_bitop3_b32 v152, v152, v42, s86 bitop3:0xf6
  v_bitop3_b32 v152, v152, v43, s87 bitop3:0xf6
  v_bitop3_b32 v152, v152, v44, s84 bitop3:0xf6
  v_bitop3_b32 v152, v152, v45, s85 bitop3:0xf6
  v_bitop3_b32 v152, v152, v46, s86 bitop3:0xf6
  v_bitop3_b32 v152, v152, v47, s87 bitop3:0xf6
  v_bitop3_b32 v152, v152, v48, s84 bitop3:0xf6
  v_bitop3_b32 v152, v152, v49, s85 bitop3:0xf6
  v_bitop3_b32 v152, v152, v50, s86 bitop3:0xf6
  v_bitop3_b32 v152, v152, v51, s87 bitop3:0xf6
  v_bitop3_b32 v152, v152, v52, s84 bitop3:0xf6
  v_bitop3_b32 v152, v152, v53, s85 bitop3:0xf6
  v_bitop3_b32 v152, v152, v54, s86 bitop3:0xf6
  v_bitop3_b32 v152, v152, v55, s87 bitop3:0xf6
  v_and_b32 v152, 0xff, v152
  v_cmp_ne_u32 vcc, 0, v152
  s_cbranch_vccz L_ok_9
  s_sub_u32 s32, s32, 1
  s_cmp_eq_u32 s32, 0
  s_cbranch_scc1 L_ok_9
  s_branch L_st2b_g
L_ok_9:
  v_mov_b32 v154, v56
  v_perm_b32 v24, v24, v1, s88
  v_perm_b32 v25, v25, v1, s88
  v_max_f32_dpp v154, v154, v154 quad_perm:[1,0,3,2] row_mask:0xf bank_mask:0xf
  v_perm_b32 v26, v26, v1, s88
  v_perm_b32 v27, v27, v1, s88
  v_max_f32_dpp v154, v154, v154 quad_perm:[2,3,0,1] row_mask:0xf bank_mask:0xf
  v_perm_b32 v28, v28, v1, s88
  v_perm_b32 v29, v29, v1, s88
  v_max_f32_dpp v154, v154, v154 row_half_mirror row_mask:0xf bank_mask:0xf
  v_sub_f32 v155, v56, v154
  v_mul_f32 v155, s30, v155
  v_exp_f32 v155, v155
  v_lshlrev_b32 v6, 3, v0
  v_mul_f32 v156, v155, v58
  v_perm_b32 v30, v30, v1, s88
  v_perm_b32 v31, v31, v1, s88
  v_add_f32_dpp v156, v156, v156 quad_perm:[1,0,3,2] row_mask:0xf bank_mask:0xf
  v_perm_b32 v32, v32, v1, s88
  v_perm_b32 v33, v33, v1, s88
  v_add_f32_dpp v156, v156, v156 quad_perm:[2,3,0,1] row_mask:0xf bank_mask:0xf
  v_perm_b32 v34, v34, v1, s88
  v_perm_b32 v35, v35, v1, s88
  v_add_f32_dpp v156, v156, v156 row_half_mirror row_mask:0xf bank_mask:0xf
  v_rcp_f32 v156, v156
  v_perm_b32 v36, v36, v1, s88
  v_perm_b32 v37, v37, v1, s88
  v_perm_b32 v38, v38, v1, s88
  v_perm_b32 v39, v39, v1, s88
  v_perm_b32 v40, v40, v1, s88
  v_perm_b32 v41, v41, v1, s88
  v_perm_b32 v42, v42, v1, s88
  v_perm_b32 v43, v43, v1, s88
  v_perm_b32 v44, v44, v1, s88
  v_perm_b32 v45, v45, v1, s88
  v_perm_b32 v46, v46, v1, s88
  v_perm_b32 v47, v47, v1, s88
  v_perm_b32 v48, v48, v1, s88
  v_perm_b32 v49, v49, v1, s88
  v_perm_b32 v50, v50, v1, s88
  v_perm_b32 v51, v51, v1, s88
  v_perm_b32 v52, v52, v1, s88
  v_perm_b32 v53, v53, v1, s88
  v_perm_b32 v54, v54, v1, s88
  v_perm_b32 v55, v55, v1, s88
  v_mul_f32 v155, v18, v155
  v_and_b32 v7, 3, v3
  v_mul_f32 v155, v155, v156
  v_lshlrev_b32 v7, 7, v7
  v_lshl_add_u32 v7, v2, 4, v7
  v_mul_f32_dpp v156, v155, v24 row_newbcast:0 row_mask:0xf bank_mask:0xf
  v_mul_f32_dpp v157, v155, v25 row_newbcast:0 row_mask:0xf bank_mask:0xf
  v_mul_f32_dpp v158, v155, v26 row_newbcast:0 row_mask:0xf bank_mask:0xf
  v_mul_f32_dpp v159, v155, v27 row_newbcast:0 row_mask:0xf bank_mask:0xf
  v_fmac_f32_dpp v156, v155, v28 row_newbcast:1 row_mask:0xf bank_mask:0xf
  v_fmac_f32_dpp v157, v155, v29 row_newbcast:1 row_mask:0xf bank_mask:0xf
  v_fmac_f32_dpp v158, v155, v30 row_newbcast:1 row_mask:0xf bank_mask:0xf
  v_fmac_f32_dpp v159, v155, v31 row_newbcast:1 row_mask:0xf bank_mask:0xf
  v_fmac_f32_dpp v156, v155, v32 row_newbcast:2 row_mask:0xf bank_mask:0xf
  v_fmac_f32_dpp v157, v155, v33 row_newbcast:2 row_mask:0xf bank_mask:0xf
  v_fmac_f32_dpp v158, v155, v34 row_newbcast:2 row_mask:0xf bank_mask:0xf
  v_fmac_f32_dpp v159, v155, v35 row_newbcast:2 row_mask:0xf bank_mask:0xf
  v_fmac_f32_dpp v156, v155, v36 row_newbcast:3 row_mask:0xf bank_mask:0xf
  v_fmac_f32_dpp v157, v155, v37 row_newbcast:3 row_mask:0xf bank_mask:0xf
  v_fmac_f32_dpp v158, v155, v38 row_newbcast:3 row_mask:0xf bank_mask:0xf
  v_fmac_f32_dpp v159, v155, v39 row_newbcast:3 row_mask:0xf bank_mask:0xf
  v_fmac_f32_dpp v156, v155, v40 row_newbcast:4 row_mask:0xf bank_mask:0xf
  v_fmac_f32_dpp v157, v155, v41 row_newbcast:4 row_mask:0xf bank_mask:0xf
  v_fmac_f32_dpp v158, v155, v42 row_newbcast:4 row_mask:0xf bank_mask:0xf
  v_fmac_f32_dpp v159, v155, v43 row_newbcast:4 row_mask:0xf bank_mask:0xf
  v_fmac_f32_dpp v156, v155, v44 row_newbcast:5 row_mask:0xf bank_mask:0xf
  v_fmac_f32_dpp v157, v155, v45 row_newbcast:5 row_mask:0xf bank_mask:0xf
  v_fmac_f32_dpp v158, v155, v46 row_newbcast:5 row_mask:0xf bank_mask:0xf
  v_fmac_f32_dpp v159, v155, v47 row_newbcast:5 row_mask:0xf bank_mask:0xf
  v_fmac_f32_dpp v156, v155, v48 row_newbcast:6 row_mask:0xf bank_mask:0xf
  v_fmac_f32_dpp v157, v155, v49 row_newbcast:6 row_mask:0xf bank_mask:0xf
  v_fmac_f32_dpp v158, v155, v50 row_newbcast:6 row_mask:0xf bank_mask:0xf
  v_fmac_f32_dpp v159, v155, v51 row_newbcast:6 row_mask:0xf bank_mask:0xf
  v_fmac_f32_dpp v156, v155, v52 row_newbcast:7 row_mask:0xf bank_mask:0xf
  v_fmac_f32_dpp v157, v155, v53 row_newbcast:7 row_mask:0xf bank_mask:0xf
  v_fmac_f32_dpp v158, v155, v54 row_newbcast:7 row_mask:0xf bank_mask:0xf
  v_fmac_f32_dpp v159, v155, v55 row_newbcast:7 row_mask:0xf bank_mask:0xf
  v_cvt_pk_bf16_f32 v156, v156, v157
  v_cvt_pk_bf16_f32 v157, v158, v159
  ds_write_b64 v6, v[156:157] offset:11264
  s_waitcnt lgkmcnt(0)
  ds_read_b128 v[8:11], v7 offset:11264
  ds_read_b128 v[12:15], v7 offset:11328
  s_waitcnt lgkmcnt(0)
  v_mfma_f32_16x16x32_bf16 v[160:163], v[8:11], v[192:195], 0
  v_mfma_f32_16x16x32_bf16 v[164:167], v[8:11], v[196:199], 0
  v_mfma_f32_16x16x32_bf16 v[168:171], v[8:11], v[200:203], 0
  v_mfma_f32_16x16x32_bf16 v[172:175], v[8:11], v[204:207], 0
  v_mfma_f32_16x16x32_bf16 v[176:179], v[8:11], v[208:211], 0
  v_mfma_f32_16x16x32_bf16 v[180:183], v[8:11], v[212:215], 0
  v_mfma_f32_16x16x32_bf16 v[184:187], v[8:11], v[216:219], 0
  v_mfma_f32_16x16x32_bf16 v[188:191], v[8:11], v[220:223], 0
  v_mfma_f32_16x16x32_bf16 v[160:163], v[12:15], v[224:227], v[160:163]
  v_mfma_f32_16x16x32_bf16 v[164:167], v[12:15], v[228:231], v[164:167]
  v_mfma_f32_16x16x32_bf16 v[168:171], v[12:15], v[232:235], v[168:171]
  v_mfma_f32_16x16x32_bf16 v[172:175], v[12:15], v[236:239], v[172:175]
  v_mfma_f32_16x16x32_bf16 v[176:179], v[12:15], v[240:243], v[176:179]
  v_mfma_f32_16x16x32_bf16 v[180:183], v[12:15], v[244:247], v[180:183]
  v_mfma_f32_16x16x32_bf16 v[184:187], v[12:15], v[248:251], v[184:187]
  v_mfma_f32_16x16x32_bf16 v[188:191], v[12:15], v[252:255], v[188:191]
  v_lshlrev_b32 v6, 5, v0
  s_nop 6
  v_cndmask_b32 v24, v160, v161, s[22:23]
  v_cndmask_b32 v25, v164, v165, s[22:23]
  v_cndmask_b32 v26, v168, v169, s[22:23]
  v_cndmask_b32 v27, v172, v173, s[22:23]
  v_cndmask_b32 v28, v176, v177, s[22:23]
  v_cndmask_b32 v29, v180, v181, s[22:23]
  v_cndmask_b32 v30, v184, v185, s[22:23]
  v_cndmask_b32 v31, v188, v189, s[22:23]
  v_cndmask_b32 v24, v24, v162, s[24:25]
  v_cndmask_b32 v25, v25, v166, s[24:25]
  v_cndmask_b32 v26, v26, v170, s[24:25]
  v_cndmask_b32 v27, v27, v174, s[24:25]
  v_cndmask_b32 v28, v28, v178, s[24:25]
  v_cndmask_b32 v29, v29, v182, s[24:25]
  v_cndmask_b32 v30, v30, v186, s[24:25]
  v_cndmask_b32 v31, v31, v190, s[24:25]
  v_cndmask_b32 v24, v24, v163, s[26:27]
  v_cndmask_b32 v25, v25, v167, s[26:27]
  v_cndmask_b32 v26, v26, v171, s[26:27]
  v_cndmask_b32 v27, v27, v175, s[26:27]
  v_cndmask_b32 v28, v28, v179, s[26:27]
  v_cndmask_b32 v29, v29, v183, s[26:27]
  v_cndmask_b32 v30, v30, v187, s[26:27]
  v_cndmask_b32 v31, v31, v191, s[26:27]
  ds_write_b128 v6, v[24:27] offset:11840
  ds_write_b128 v6, v[28:31] offset:11856
  s_waitcnt lgkmcnt(0)
  s_barrier
L_hend:
  s_waitcnt vmcnt(0)
L_end:
  s_endpgm
L_code_end:
.section .rodata,"a"
.p2align 6
.amdhsa_kernel gated_mix__mha_block_cached__gqa_block_cached__decode_kernel
  .amdhsa_next_free_vgpr 320
  .amdhsa_next_free_sgpr 96
  .amdhsa_accum_offset 256
  .amdhsa_group_segment_fixed_size 0
  .amdhsa_kernarg_size 112
  .amdhsa_user_sgpr_count 2
  .amdhsa_user_sgpr_kernarg_segment_ptr 1
  .amdhsa_system_sgpr_workgroup_id_x 1
  .amdhsa_float_denorm_mode_32 3
.end_amdhsa_kernel
```
